```python
import torch

def _softmax(x, axis=-1):
    return torch.softmax(x, dim=axis)
def _gelu(x):
    return torch.nn.functional.gelu(x, approximate="tanh")
def _silu(x):
    return torch.nn.functional.silu(x)
def _sigmoid(x):
    return torch.sigmoid(x)
def _layernorm(x, axis=-1, eps=1e-5):
    m = x.mean(dim=axis, keepdim=True)
    v = x.var(dim=axis, keepdim=True, unbiased=False)
    return (x - m) / torch.sqrt(v + eps)
def _scatter_add(tgt, idx, src, axis=0):
    return tgt.clone().index_add_(axis, idx, src)
def _segment_sum(src, seg, n):
    out = torch.zeros((n,) + src.shape[1:], dtype=src.dtype)
    return out.index_add_(0, seg, src)
def _pad(x, pw):
    flat = tuple(v for pair in reversed(pw) for v in pair)
    return torch.nn.functional.pad(x, flat)

kernel_name = 'parallel_sum__gqa_block_cached__swiglu_ffn__decode'

def setup_inputs():

    _w = (lambda a: (lambda t: t.to(torch.bfloat16) if t.is_floating_point() else t)(torch.as_tensor(a)))
    def _A_setup():
        B, Sq, D = 2, 1, 1024
        Hq, Hkv, Sk, Dh = 32, 4, 32768, 128
        assert Hq % Hkv == 0, (Hq, Hkv)
        return {
            "x": _w((lambda *s: torch.randn(*s, dtype=torch.bfloat16) * 0.05)(B, Sq, D)),
            "k_cache": _w((lambda *s: torch.randn(*s, dtype=torch.bfloat16) * 3.2)(B, Hkv, Sk, Dh)),
            "v_cache": _w((lambda *s: torch.randn(*s, dtype=torch.bfloat16) * 1.6)(B, Hkv, Sk, Dh)),
            "wq": _w((lambda *s: torch.randn(*s, dtype=torch.bfloat16) * 3.2)(D, Hq * Dh) * (D ** -0.5)),
            "wo": _w((lambda *s: torch.randn(*s, dtype=torch.bfloat16) * 1.6)(Hq * Dh, D) * ((Hq * Dh) ** -0.5)),
        }
    _A_in = _A_setup()

    def _B_setup():
        B, S, D, F = 2, 1, 1024, 3584
        return {
            "x": _w((lambda *s: torch.randn(*s, dtype=torch.bfloat16) * 0.05)(B, S, D)),
            "w_gate": _w((lambda *s: torch.randn(*s, dtype=torch.bfloat16) * 0.05)(D, F)),
            "w_up": _w((lambda *s: torch.randn(*s, dtype=torch.bfloat16) * 0.05)(D, F)),
            "w_down": _w((lambda *s: torch.randn(*s, dtype=torch.bfloat16) * 0.05)(F, D)),
        }
    _B_in = _B_setup()

    return {
        "A_x": _A_in["x"],
        "A_k_cache": _A_in["k_cache"],
        "A_v_cache": _A_in["v_cache"],
        "A_wq": _A_in["wq"],
        "A_wo": _A_in["wo"],
        "B_x": _B_in["x"],
        "B_w_gate": _B_in["w_gate"],
        "B_w_up": _B_in["w_up"],
        "B_w_down": _B_in["w_down"],
    }

def reference(A_x, A_k_cache, A_v_cache, A_wq, A_wo, B_x, B_w_gate, B_w_up, B_w_down):
    def _A_ref(x, k_cache, v_cache, wq, wo):
        B, Sq, D = x.shape
        Hq, Dh = 32, 128
        Hkv = k_cache.shape[1]
        rep = Hq // Hkv
        q = (lambda x, *d: x.permute(*d))((x @ wq).reshape(B, Sq, Hq, Dh), 0, 2, 1, 3)
        k = (lambda x, n, axis: torch.repeat_interleave(x, n, dim=axis))(k_cache, rep, axis=1)
        v = (lambda x, n, axis: torch.repeat_interleave(x, n, dim=axis))(v_cache, rep, axis=1)
        scores = torch.einsum("bhqd,bhkd->bhqk", q, k) * (Dh ** -0.5)
        p = _softmax(scores, axis=-1)
        o = torch.einsum("bhqk,bhkd->bhqd", p, v)
        return (lambda x, *d: x.permute(*d))(o, 0, 2, 1, 3).reshape(B, Sq, Hq * Dh) @ wo

    def _B_ref(x, w_gate, w_up, w_down):
        g = _silu(x @ w_gate)
        u = x @ w_up
        return (g * u) @ w_down

    x = A_x
    xn = _layernorm(x, axis=-1)
    return x + _A_ref(xn, A_k_cache, A_v_cache, A_wq, A_wo) + _B_ref(xn, B_w_gate, B_w_up, B_w_down)
```

```asm
; @launch grid=(256,1,1) block=(256,1,1) lds=151552
.amdgcn_target "amdgcn-amd-amdhsa--gfx950"
.text
.globl parallel_sum__gqa_block_cached__swiglu_ffn__decode_kernel
.p2align 8
.type parallel_sum__gqa_block_cached__swiglu_ffn__decode_kernel,@function
parallel_sum__gqa_block_cached__swiglu_ffn__decode_kernel:
    s_cmp_ge_u32 s2, 256
    s_cbranch_scc1 DONE
    s_load_dwordx16 s[52:67], s[0:1], 0
    s_load_dwordx8 s[68:75], s[0:1], 64
    v_and_b32 v1, 63, v0
    v_lshrrev_b32 v224, 6, v0
    s_nop 0
    v_readfirstlane_b32 s3, v224
    s_and_b32 s4, s2, 7
    s_lshr_b32 s5, s2, 3
    s_and_b32 s7, s5, 1
    s_lshr_b32 s6, s5, 1
    s_add_u32 s51, s4, 1
    s_and_b32 s51, s51, 3
    s_lshl_b32 s51, s51, 1
    s_lshr_b32 s8, s4, 2
    s_add_u32 s51, s51, s8
    s_lshl_b32 s51, s51, 4
    s_add_u32 s6, s6, s51
    s_add_u32 s89, s5, 0
    s_and_b32 s89, s89, 31
    v_and_b32 v224, 15, v1
    v_lshrrev_b32 v225, 4, v1
    v_and_b32 v226, 1, v1
    s_waitcnt lgkmcnt(0)
    s_mov_b64 s[40:41], s[52:53]
    s_mov_b32 s42, 4096
    s_mov_b32 s43, 0x20000
    s_mov_b64 s[16:17], s[58:59]
    s_mov_b32 s18, 8388608
    s_mov_b32 s19, 0x20000
    s_load_dword s48, s[74:75], 0
    v_lshlrev_b32 v227, 6, v1
    buffer_load_dwordx4 v[64:67], v227, s[40:43], 0 offen offset:0
    buffer_load_dwordx4 v[68:71], v227, s[40:43], 0 offen offset:16
    buffer_load_dwordx4 v[72:75], v227, s[40:43], 0 offen offset:32
    buffer_load_dwordx4 v[76:79], v227, s[40:43], 0 offen offset:48
    s_lshl_b32 s90, s4, 7
    s_lshl_b32 s91, s3, 5
    s_add_u32 s90, s90, s91
    s_lshl_b32 s92, s90, 1
    v_lshlrev_b32 v228, 11, v226
    v_lshl_add_u32 v228, v225, 3, v228
    buffer_load_dwordx2 v[80:81], v228, s[40:43], s92 offen
    buffer_load_dwordx2 v[82:83], v228, s[40:43], s92 offen offset:32
    s_lshl_b32 s49, s3, 15
    s_lshl_b32 s91, s89, 8
    s_lshl_b32 s86, s90, 13
    s_add_u32 s86, s86, s91
    v_add_u32 v229, 0, v225
    v_lshlrev_b32 v230, 1, v229
    v_xor_b32 v230, v230, v224
    v_lshlrev_b32 v230, 4, v230
    v_mul_u32_u24 v229, 8192, v229
    v_add_u32 v20, v229, v230
    v_add_u32 v229, 4, v225
    v_lshlrev_b32 v230, 1, v229
    v_xor_b32 v230, v230, v224
    v_lshlrev_b32 v230, 4, v230
    v_mul_u32_u24 v229, 8192, v229
    v_add_u32 v21, v229, v230
    v_subrev_u32 v21, 1024, v21
    s_add_u32 m0, s49, 0
    s_add_u32 s51, s86, 0
    buffer_load_dwordx4 v20, s[16:19], s51 offen nt lds
    buffer_load_dwordx4 v21, s[16:19], s51 offen offset:1024 nt lds
    s_add_u32 m0, s49, 2048
    s_add_u32 s51, s86, 65536
    buffer_load_dwordx4 v20, s[16:19], s51 offen nt lds
    buffer_load_dwordx4 v21, s[16:19], s51 offen offset:1024 nt lds
    s_add_u32 m0, s49, 4096
    s_add_u32 s51, s86, 131072
    buffer_load_dwordx4 v20, s[16:19], s51 offen nt lds
    buffer_load_dwordx4 v21, s[16:19], s51 offen offset:1024 nt lds
    s_add_u32 m0, s49, 6144
    s_add_u32 s51, s86, 196608
    buffer_load_dwordx4 v20, s[16:19], s51 offen nt lds
    buffer_load_dwordx4 v21, s[16:19], s51 offen offset:1024 nt lds
    s_mov_b64 s[20:21], s[64:65]
    s_mov_b32 s22, 7340032
    s_mov_b32 s23, 0x20000
    s_mov_b64 s[24:25], s[66:67]
    s_mov_b32 s26, 7340032
    s_mov_b32 s27, 0x20000
    s_mul_i32 s87, s90, 7168
    s_add_u32 s63, s89, 1
    s_and_b32 s63, s63, 31
    s_add_u32 s99, s89, 2
    s_and_b32 s99, s99, 31
    s_lshl_b32 s91, s99, 8
    s_add_u32 s62, s87, s91
    s_lshl_b32 s91, s63, 8
    s_add_u32 s87, s87, s91
    s_cmp_ge_u32 s63, 28
    s_cselect_b32 s87, 0, s87
    s_cselect_b32 s22, 0, s22
    s_cmp_ge_u32 s99, 28
    s_cselect_b32 s62, 0, s62
    s_cselect_b32 s26, 0, s26
    v_add_u32 v229, 0, v225
    v_lshlrev_b32 v230, 1, v229
    v_xor_b32 v230, v230, v224
    v_lshlrev_b32 v230, 4, v230
    v_mul_u32_u24 v229, 7168, v229
    v_add_u32 v22, v229, v230
    v_add_u32 v229, 4, v225
    v_lshlrev_b32 v230, 1, v229
    v_xor_b32 v230, v230, v224
    v_lshlrev_b32 v230, 4, v230
    v_mul_u32_u24 v229, 7168, v229
    v_add_u32 v23, v229, v230
    v_subrev_u32 v23, 1024, v23
    s_add_u32 m0, s49, 8192
    s_add_u32 s51, s87, 0
    buffer_load_dwordx4 v22, s[20:23], s51 offen nt lds
    buffer_load_dwordx4 v23, s[20:23], s51 offen offset:1024 nt lds
    s_add_u32 m0, s49, 10240
    s_add_u32 s51, s87, 57344
    buffer_load_dwordx4 v22, s[20:23], s51 offen nt lds
    buffer_load_dwordx4 v23, s[20:23], s51 offen offset:1024 nt lds
    s_add_u32 m0, s49, 12288
    s_add_u32 s51, s87, 114688
    buffer_load_dwordx4 v22, s[20:23], s51 offen nt lds
    buffer_load_dwordx4 v23, s[20:23], s51 offen offset:1024 nt lds
    s_add_u32 m0, s49, 14336
    s_add_u32 s51, s87, 172032
    buffer_load_dwordx4 v22, s[20:23], s51 offen nt lds
    buffer_load_dwordx4 v23, s[20:23], s51 offen offset:1024 nt lds
    s_mov_b64 s[36:37], s[74:75]
    s_mov_b32 s38, 16777216
    s_mov_b32 s39, 0x20000
    s_mov_b64 s[8:9], s[54:55]
    s_mov_b32 s10, 67108864
    s_mov_b32 s11, 0x20000
    s_mov_b64 s[12:13], s[56:57]
    s_mov_b32 s14, 67108864
    s_mov_b32 s15, 0x20000
    s_mov_b64 s[28:29], s[60:61]
    s_mov_b32 s30, 8388608
    s_mov_b32 s31, 0x20000
    s_mov_b64 s[32:33], s[68:69]
    s_mov_b32 s34, 7340032
    s_mov_b32 s35, 0x20000
    s_mov_b64 s[44:45], s[70:71]
    s_mov_b32 s46, 4096
    s_mov_b32 s47, 0x20000
    s_lshl_b32 s50, s4, 23
    s_lshl_b32 s90, s5, 18
    s_add_u32 s50, s50, s90
    s_lshl_b32 s90, s3, 13
    s_add_u32 s50, s50, s90
    s_lshl_b32 s88, s6, 16
    s_lshl_b32 s90, s7, 10
    s_add_u32 s88, s88, s90
    s_lshl_b32 s90, s3, 8
    s_add_u32 s88, s88, s90
    s_cmp_ge_u32 s6, 112
    s_cselect_b32 s34, 0, s34
    v_add_u32 v229, 0, v225
    v_xor_b32 v229, v229, v224
    v_lshlrev_b32 v229, 4, v229
    v_lshl_add_u32 v2, v225, 8, v229
    v_add_u32 v229, 4, v225
    v_xor_b32 v229, v229, v224
    v_lshlrev_b32 v229, 4, v229
    v_lshl_add_u32 v3, v225, 8, v229
    v_add_u32 v229, 8, v225
    v_xor_b32 v229, v229, v224
    v_lshlrev_b32 v229, 4, v229
    v_lshl_add_u32 v4, v225, 8, v229
    v_add_u32 v229, 12, v225
    v_xor_b32 v229, v229, v224
    v_lshlrev_b32 v229, 4, v229
    v_lshl_add_u32 v5, v225, 8, v229
    v_add_u32 v229, 0, v225
    v_lshlrev_b32 v229, 1, v229
    v_xor_b32 v229, v229, v224
    v_lshlrev_b32 v229, 4, v229
    v_lshl_add_u32 v6, v225, 8, v229
    v_add_u32 v229, 4, v225
    v_lshlrev_b32 v229, 1, v229
    v_xor_b32 v229, v229, v224
    v_lshlrev_b32 v229, 4, v229
    v_lshl_add_u32 v7, v225, 8, v229
    v_add_u32 v229, 0, v225
    v_lshlrev_b32 v230, 1, v229
    v_xor_b32 v230, v230, v224
    v_lshlrev_b32 v230, 4, v230
    v_mul_u32_u24 v229, 2048, v229
    v_add_u32 v24, v229, v230
    v_add_u32 v229, 4, v225
    v_lshlrev_b32 v230, 1, v229
    v_xor_b32 v230, v230, v224
    v_lshlrev_b32 v230, 4, v230
    v_mul_u32_u24 v229, 2048, v229
    v_add_u32 v25, v229, v230
    v_subrev_u32 v25, 1024, v25
    v_lshlrev_b32 v230, 8, v224
    v_add_u32 v230, s49, v230
    v_add_u32 v229, 0, v225
    v_xor_b32 v229, v229, v224
    v_lshl_add_u32 v8, v229, 4, v230
    v_add_u32 v229, 4, v225
    v_xor_b32 v229, v229, v224
    v_lshl_add_u32 v9, v229, 4, v230
    v_add_u32 v229, 8, v225
    v_xor_b32 v229, v229, v224
    v_lshl_add_u32 v10, v229, 4, v230
    v_add_u32 v229, 12, v225
    v_xor_b32 v229, v229, v224
    v_lshl_add_u32 v11, v229, 4, v230
    v_lshrrev_b32 v229, 2, v1
    v_and_b32 v230, 7, v229
    v_lshlrev_b32 v229, 8, v229
    v_add_u32 v229, s49, v229
    v_and_b32 v231, 3, v1
    v_lshlrev_b32 v231, 3, v231
    v_add_u32 v229, v229, v231
    v_xor_b32 v231, 0, v230
    v_lshl_add_u32 v12, v231, 5, v229
    v_xor_b32 v231, 1, v230
    v_lshl_add_u32 v13, v231, 5, v229
    v_xor_b32 v231, 2, v230
    v_lshl_add_u32 v14, v231, 5, v229
    v_xor_b32 v231, 3, v230
    v_lshl_add_u32 v15, v231, 5, v229
    v_xor_b32 v231, 4, v230
    v_lshl_add_u32 v16, v231, 5, v229
    v_xor_b32 v231, 5, v230
    v_lshl_add_u32 v17, v231, 5, v229
    v_xor_b32 v231, 6, v230
    v_lshl_add_u32 v18, v231, 5, v229
    v_xor_b32 v231, 7, v230
    v_lshl_add_u32 v19, v231, 5, v229
    s_waitcnt lgkmcnt(0)
    s_lshl_b32 s90, s89, 14
    s_lshl_b32 s91, s4, 10
    s_add_u32 s90, s90, s91
    s_add_u32 s72, s90, 65536
    s_lshr_b32 s90, s4, 2
    s_and_b32 s91, s4, 3
    s_xor_b32 s90, s90, 1
    s_lshl_b32 s92, s91, 2
    s_add_u32 s92, s92, s3
    s_lshl_b32 s93, s5, 14
    s_lshl_b32 s94, s90, 13
    s_add_u32 s93, s93, s94
    s_lshl_b32 s94, s92, 6
    s_add_u32 s93, s93, s94
    s_add_u32 s73, s93, 65536
    s_lshl_b32 s93, s90, 14
    s_lshl_b32 s94, s5, 9
    s_add_u32 s93, s93, s94
    s_lshl_b32 s94, s92, 5
    s_add_u32 s93, s93, s94
    s_add_u32 s74, s93, 589824
    s_lshl_b32 s93, s4, 12
    s_add_u32 s75, s93, 589824
    s_cmp_ge_u32 s3, 2
    s_cselect_b32 s93, s99, s63
    s_lshl_b32 s93, s93, 15
    s_lshl_b32 s94, s4, 9
    s_add_u32 s93, s93, s94
    s_lshr_b32 s94, s3, 1
    s_lshl_b32 s94, s94, 12
    s_add_u32 s93, s93, s94
    s_and_b32 s94, s3, 1
    s_lshl_b32 s94, s94, 8
    s_add_u32 s93, s93, s94
    s_add_u32 s76, s93, 1048576
    s_lshl_b32 s93, s6, 13
    s_add_u32 s77, s93, 1048576
    s_lshl_b32 s93, s2, 0
    s_lshl_b32 s93, s4, 5
    s_add_u32 s93, s93, s5
    s_lshl_b32 s93, s93, 12
    s_add_u32 s78, s93, 2097152
    s_lshl_b32 s93, s4, 12
    s_lshl_b32 s94, s5, 4
    s_add_u32 s93, s93, s94
    s_add_u32 s79, s93, 4194304
    s_mov_b32 s64, 0x3db504f3
    s_mov_b32 s65, 0x3db504f3
    s_mov_b32 s66, 0x3fb8aa3b
    s_mov_b32 s67, 0x3fb8aa3b
    s_mov_b32 s68, 0xffff0000
    s_mov_b32 s52, 0x7060500
    s_mov_b32 s53, 0x7060501
    s_mov_b32 s54, 0x7060502
    s_mov_b32 s55, 0x7060503
    s_mov_b32 s56, 0x0c0c0400
    s_mov_b32 s57, 0x04000c0c
    s_mov_b32 s58, 0xffffff00
    s_waitcnt lgkmcnt(0)
    s_mul_i32 s48, s48, 1664525
    s_add_u32 s48, s48, 1013904223
    v_mov_b32 v38, s48
    s_waitcnt vmcnt(18)
    v_and_b32 v89, s68, v64
    v_lshlrev_b32 v88, 16, v64
    v_and_b32 v91, s68, v65
    v_lshlrev_b32 v90, 16, v65
    v_and_b32 v93, s68, v66
    v_lshlrev_b32 v92, 16, v66
    v_and_b32 v95, s68, v67
    v_lshlrev_b32 v94, 16, v67
    v_and_b32 v97, s68, v68
    v_lshlrev_b32 v96, 16, v68
    v_and_b32 v99, s68, v69
    v_lshlrev_b32 v98, 16, v69
    v_and_b32 v101, s68, v70
    v_lshlrev_b32 v100, 16, v70
    v_and_b32 v103, s68, v71
    v_lshlrev_b32 v102, 16, v71
    v_and_b32 v105, s68, v72
    v_lshlrev_b32 v104, 16, v72
    v_and_b32 v107, s68, v73
    v_lshlrev_b32 v106, 16, v73
    v_and_b32 v109, s68, v74
    v_lshlrev_b32 v108, 16, v74
    v_and_b32 v111, s68, v75
    v_lshlrev_b32 v110, 16, v75
    v_and_b32 v113, s68, v76
    v_lshlrev_b32 v112, 16, v76
    v_and_b32 v115, s68, v77
    v_lshlrev_b32 v114, 16, v77
    v_and_b32 v117, s68, v78
    v_lshlrev_b32 v116, 16, v78
    v_and_b32 v119, s68, v79
    v_lshlrev_b32 v118, 16, v79
    v_pk_add_f32 v[228:229], v[88:89], v[90:91]
    v_pk_add_f32 v[228:229], v[228:229], v[92:93]
    v_pk_add_f32 v[228:229], v[228:229], v[94:95]
    v_pk_add_f32 v[228:229], v[228:229], v[96:97]
    v_pk_add_f32 v[228:229], v[228:229], v[98:99]
    v_pk_add_f32 v[228:229], v[228:229], v[100:101]
    v_pk_add_f32 v[228:229], v[228:229], v[102:103]
    v_pk_add_f32 v[228:229], v[228:229], v[104:105]
    v_pk_add_f32 v[228:229], v[228:229], v[106:107]
    v_pk_add_f32 v[228:229], v[228:229], v[108:109]
    v_pk_add_f32 v[228:229], v[228:229], v[110:111]
    v_pk_add_f32 v[228:229], v[228:229], v[112:113]
    v_pk_add_f32 v[228:229], v[228:229], v[114:115]
    v_pk_add_f32 v[228:229], v[228:229], v[116:117]
    v_pk_add_f32 v[228:229], v[228:229], v[118:119]
    v_add_f32 v228, v228, v229
    s_nop 1
    v_add_f32_dpp v228, v228, v228 row_ror:8 row_mask:0xf bank_mask:0xf
    s_nop 1
    v_add_f32_dpp v228, v228, v228 row_ror:4 row_mask:0xf bank_mask:0xf
    s_nop 1
    v_add_f32_dpp v228, v228, v228 row_ror:2 row_mask:0xf bank_mask:0xf
    s_nop 1
    v_add_f32_dpp v228, v228, v228 row_ror:1 row_mask:0xf bank_mask:0xf
    v_mov_b32 v229, v228
    s_nop 1
    v_permlane16_swap_b32 v228, v229
    v_add_f32 v228, v228, v229
    v_mul_f32 v228, 0x3a800000, v228
    v_mov_b32 v229, v228
    v_pk_add_f32 v[88:89], v[88:89], v[228:229] neg_lo:[0,1] neg_hi:[0,1]
    v_pk_add_f32 v[90:91], v[90:91], v[228:229] neg_lo:[0,1] neg_hi:[0,1]
    v_pk_add_f32 v[92:93], v[92:93], v[228:229] neg_lo:[0,1] neg_hi:[0,1]
    v_pk_add_f32 v[94:95], v[94:95], v[228:229] neg_lo:[0,1] neg_hi:[0,1]
    v_pk_add_f32 v[96:97], v[96:97], v[228:229] neg_lo:[0,1] neg_hi:[0,1]
    v_pk_add_f32 v[98:99], v[98:99], v[228:229] neg_lo:[0,1] neg_hi:[0,1]
    v_pk_add_f32 v[100:101], v[100:101], v[228:229] neg_lo:[0,1] neg_hi:[0,1]
    v_pk_add_f32 v[102:103], v[102:103], v[228:229] neg_lo:[0,1] neg_hi:[0,1]
    v_pk_add_f32 v[104:105], v[104:105], v[228:229] neg_lo:[0,1] neg_hi:[0,1]
    v_pk_add_f32 v[106:107], v[106:107], v[228:229] neg_lo:[0,1] neg_hi:[0,1]
    v_pk_add_f32 v[108:109], v[108:109], v[228:229] neg_lo:[0,1] neg_hi:[0,1]
    v_pk_add_f32 v[110:111], v[110:111], v[228:229] neg_lo:[0,1] neg_hi:[0,1]
    v_pk_add_f32 v[112:113], v[112:113], v[228:229] neg_lo:[0,1] neg_hi:[0,1]
    v_pk_add_f32 v[114:115], v[114:115], v[228:229] neg_lo:[0,1] neg_hi:[0,1]
    v_pk_add_f32 v[116:117], v[116:117], v[228:229] neg_lo:[0,1] neg_hi:[0,1]
    v_pk_add_f32 v[118:119], v[118:119], v[228:229] neg_lo:[0,1] neg_hi:[0,1]
    v_pk_mul_f32 v[230:231], v[88:89], v[88:89]
    v_pk_fma_f32 v[230:231], v[90:91], v[90:91], v[230:231]
    v_pk_fma_f32 v[230:231], v[92:93], v[92:93], v[230:231]
    v_pk_fma_f32 v[230:231], v[94:95], v[94:95], v[230:231]
    v_pk_fma_f32 v[230:231], v[96:97], v[96:97], v[230:231]
    v_pk_fma_f32 v[230:231], v[98:99], v[98:99], v[230:231]
    v_pk_fma_f32 v[230:231], v[100:101], v[100:101], v[230:231]
    v_pk_fma_f32 v[230:231], v[102:103], v[102:103], v[230:231]
    v_pk_fma_f32 v[230:231], v[104:105], v[104:105], v[230:231]
    v_pk_fma_f32 v[230:231], v[106:107], v[106:107], v[230:231]
    v_pk_fma_f32 v[230:231], v[108:109], v[108:109], v[230:231]
    v_pk_fma_f32 v[230:231], v[110:111], v[110:111], v[230:231]
    v_pk_fma_f32 v[230:231], v[112:113], v[112:113], v[230:231]
    v_pk_fma_f32 v[230:231], v[114:115], v[114:115], v[230:231]
    v_pk_fma_f32 v[230:231], v[116:117], v[116:117], v[230:231]
    v_pk_fma_f32 v[230:231], v[118:119], v[118:119], v[230:231]
    v_add_f32 v230, v230, v231
    s_nop 1
    v_add_f32_dpp v230, v230, v230 row_ror:8 row_mask:0xf bank_mask:0xf
    s_nop 1
    v_add_f32_dpp v230, v230, v230 row_ror:4 row_mask:0xf bank_mask:0xf
    s_nop 1
    v_add_f32_dpp v230, v230, v230 row_ror:2 row_mask:0xf bank_mask:0xf
    s_nop 1
    v_add_f32_dpp v230, v230, v230 row_ror:1 row_mask:0xf bank_mask:0xf
    v_mov_b32 v231, v230
    s_nop 1
    v_permlane16_swap_b32 v230, v231
    v_add_f32 v230, v230, v231
    v_mul_f32 v230, 0x3a800000, v230
    v_cvt_pk_bf16_f32 v228, v228, v230
    v_and_b32 v230, s68, v228
    v_lshlrev_b32 v229, 16, v228
    v_add_f32 v230, 0x3727c5ac, v230
    v_cvt_pk_bf16_f32 v230, v230, v230
    v_and_b32 v230, s68, v230
    v_sqrt_f32 v230, v230
    s_nop 0
    v_cvt_pk_bf16_f32 v230, v230, v230
    v_and_b32 v230, s68, v230
    v_readlane_b32 s90, v229, 0
    v_readlane_b32 s91, v229, 32
    v_readlane_b32 s92, v230, 0
    v_readlane_b32 s93, v230, 32
    v_cmp_eq_u32 vcc, 1, v226
    v_mov_b32 v228, s90
    v_mov_b32 v229, s91
    v_cndmask_b32 v228, v228, v229, vcc
    v_mov_b32 v230, s92
    v_mov_b32 v231, s93
    v_cndmask_b32 v230, v230, v231, vcc
    v_rcp_f32 v231, v230
    s_waitcnt vmcnt(16)
    v_and_b32 v89, s68, v80
    v_lshlrev_b32 v88, 16, v80
    v_and_b32 v91, s68, v81
    v_lshlrev_b32 v90, 16, v81
    v_and_b32 v93, s68, v82
    v_lshlrev_b32 v92, 16, v82
    v_and_b32 v95, s68, v83
    v_lshlrev_b32 v94, 16, v83
    v_sub_f32 v88, v88, v228
    v_sub_f32 v89, v89, v228
    v_sub_f32 v90, v90, v228
    v_sub_f32 v91, v91, v228
    v_sub_f32 v92, v92, v228
    v_sub_f32 v93, v93, v228
    v_sub_f32 v94, v94, v228
    v_sub_f32 v95, v95, v228
    v_cvt_pk_bf16_f32 v80, v88, v89
    v_and_b32 v89, s68, v80
    v_lshlrev_b32 v88, 16, v80
    v_cvt_pk_bf16_f32 v81, v90, v91
    v_and_b32 v91, s68, v81
    v_lshlrev_b32 v90, 16, v81
    v_cvt_pk_bf16_f32 v82, v92, v93
    v_and_b32 v93, s68, v82
    v_lshlrev_b32 v92, 16, v82
    v_cvt_pk_bf16_f32 v83, v94, v95
    v_and_b32 v95, s68, v83
    v_lshlrev_b32 v94, 16, v83
    v_mul_f32 v96, v88, v231
    v_fma_f32 v88, -v96, v230, v88
    v_fma_f32 v88, v88, v231, v96
    v_mul_f32 v97, v89, v231
    v_fma_f32 v89, -v97, v230, v89
    v_fma_f32 v89, v89, v231, v97
    v_mul_f32 v98, v90, v231
    v_fma_f32 v90, -v98, v230, v90
    v_fma_f32 v90, v90, v231, v98
    v_mul_f32 v99, v91, v231
    v_fma_f32 v91, -v99, v230, v91
    v_fma_f32 v91, v91, v231, v99
    v_mul_f32 v100, v92, v231
    v_fma_f32 v92, -v100, v230, v92
    v_fma_f32 v92, v92, v231, v100
    v_mul_f32 v101, v93, v231
    v_fma_f32 v93, -v101, v230, v93
    v_fma_f32 v93, v93, v231, v101
    v_mul_f32 v102, v94, v231
    v_fma_f32 v94, -v102, v230, v94
    v_fma_f32 v94, v94, v231, v102
    v_mul_f32 v103, v95, v231
    v_fma_f32 v95, -v103, v230, v95
    v_fma_f32 v95, v95, v231, v103
    v_cvt_pk_bf16_f32 v26, v88, v89
    v_cvt_pk_bf16_f32 v27, v90, v91
    v_cvt_pk_bf16_f32 v28, v92, v93
    v_cvt_pk_bf16_f32 v29, v94, v95
    s_lshl_b32 s90, s3, 10
    s_add_u32 s90, s90, 131072
    v_lshlrev_b32 v56, 9, v226
    v_lshl_add_u32 v56, v225, 4, v56
    v_add_u32 v56, s90, v56
    v_lshlrev_b32 v59, 4, v0
    v_mul_u32_u24 v60, 272, v224
    v_lshl_add_u32 v60, v225, 4, v60
    s_waitcnt vmcnt(8)
    s_add_u32 m0, s49, 16384
    s_add_u32 s51, s62, 0
    buffer_load_dwordx4 v22, s[24:27], s51 offen nt lds
    buffer_load_dwordx4 v23, s[24:27], s51 offen offset:1024 nt lds
    s_add_u32 m0, s49, 18432
    s_add_u32 s51, s62, 57344
    buffer_load_dwordx4 v22, s[24:27], s51 offen nt lds
    buffer_load_dwordx4 v23, s[24:27], s51 offen offset:1024 nt lds
    ds_read_b64_tr_b16 v[192:193], v12 offset:0
    ds_read_b64_tr_b16 v[194:195], v12 offset:4096
    ds_read_b64_tr_b16 v[196:197], v13 offset:0
    ds_read_b64_tr_b16 v[198:199], v13 offset:4096
    ds_read_b64_tr_b16 v[200:201], v14 offset:0
    ds_read_b64_tr_b16 v[202:203], v14 offset:4096
    ds_read_b64_tr_b16 v[204:205], v15 offset:0
    ds_read_b64_tr_b16 v[206:207], v15 offset:4096
    ds_read_b64_tr_b16 v[208:209], v16 offset:0
    ds_read_b64_tr_b16 v[210:211], v16 offset:4096
    ds_read_b64_tr_b16 v[212:213], v17 offset:0
    ds_read_b64_tr_b16 v[214:215], v17 offset:4096
    ds_read_b64_tr_b16 v[216:217], v18 offset:0
    ds_read_b64_tr_b16 v[218:219], v18 offset:4096
    ds_read_b64_tr_b16 v[220:221], v19 offset:0
    ds_read_b64_tr_b16 v[222:223], v19 offset:4096
    s_waitcnt lgkmcnt(0)
    v_mfma_f32_16x16x32_bf16 v[160:163], v[192:195], v[26:29], 0
    v_mfma_f32_16x16x32_bf16 v[164:167], v[196:199], v[26:29], 0
    v_mfma_f32_16x16x32_bf16 v[168:171], v[200:203], v[26:29], 0
    v_mfma_f32_16x16x32_bf16 v[172:175], v[204:207], v[26:29], 0
    v_mfma_f32_16x16x32_bf16 v[176:179], v[208:211], v[26:29], 0
    v_mfma_f32_16x16x32_bf16 v[180:183], v[212:215], v[26:29], 0
    v_mfma_f32_16x16x32_bf16 v[184:187], v[216:219], v[26:29], 0
    v_mfma_f32_16x16x32_bf16 v[188:191], v[220:223], v[26:29], 0
    s_mov_b64 s[70:71], exec
    s_mov_b32 exec_lo, 0x00030003
    s_mov_b32 exec_hi, 0x00030003
    ds_write_b128 v56, v[160:163] offset:0
    ds_write_b128 v56, v[164:167] offset:64
    ds_write_b128 v56, v[168:171] offset:128
    ds_write_b128 v56, v[172:175] offset:192
    ds_write_b128 v56, v[176:179] offset:256
    ds_write_b128 v56, v[180:183] offset:320
    ds_write_b128 v56, v[184:187] offset:384
    ds_write_b128 v56, v[188:191] offset:448
    s_mov_b64 exec, s[70:71]
    s_waitcnt lgkmcnt(0)
    s_barrier
    v_lshlrev_b32 v239, 2, v0
    v_add_u32 v239, 131072, v239
    ds_read_b32 v232, v239 offset:0
    ds_read_b32 v233, v239 offset:1024
    ds_read_b32 v234, v239 offset:2048
    ds_read_b32 v235, v239 offset:3072
    v_and_b32 v238, 127, v0
    v_lshlrev_b32 v238, 3, v238
    v_lshrrev_b32 v237, 7, v0
    v_lshl_add_u32 v238, v237, 13, v238
    s_waitcnt lgkmcnt(0)
    v_add_f32 v232, v232, v233
    v_add_f32 v234, v234, v235
    v_add_f32 v232, v232, v234
    v_mov_b32 v233, v38
    buffer_store_dwordx2 v[232:233], v238, s[36:39], s72 offen sc1
    s_waitcnt vmcnt(5)
    ds_read_b64_tr_b16 v[192:193], v12 offset:8192
    ds_read_b64_tr_b16 v[194:195], v12 offset:12288
    ds_read_b64_tr_b16 v[196:197], v13 offset:8192
    ds_read_b64_tr_b16 v[198:199], v13 offset:12288
    ds_read_b64_tr_b16 v[200:201], v14 offset:8192
    ds_read_b64_tr_b16 v[202:203], v14 offset:12288
    ds_read_b64_tr_b16 v[204:205], v15 offset:8192
    ds_read_b64_tr_b16 v[206:207], v15 offset:12288
    ds_read_b64_tr_b16 v[208:209], v16 offset:8192
    ds_read_b64_tr_b16 v[210:211], v16 offset:12288
    ds_read_b64_tr_b16 v[212:213], v17 offset:8192
    ds_read_b64_tr_b16 v[214:215], v17 offset:12288
    ds_read_b64_tr_b16 v[216:217], v18 offset:8192
    ds_read_b64_tr_b16 v[218:219], v18 offset:12288
    ds_read_b64_tr_b16 v[220:221], v19 offset:8192
    ds_read_b64_tr_b16 v[222:223], v19 offset:12288
    s_waitcnt lgkmcnt(0)
    s_add_u32 m0, s49, 20480
    s_add_u32 s51, s62, 114688
    buffer_load_dwordx4 v22, s[24:27], s51 offen nt lds
    buffer_load_dwordx4 v23, s[24:27], s51 offen offset:1024 nt lds
    s_add_u32 m0, s49, 22528
    s_add_u32 s51, s62, 172032
    buffer_load_dwordx4 v22, s[24:27], s51 offen nt lds
    buffer_load_dwordx4 v23, s[24:27], s51 offen offset:1024 nt lds
    s_add_u32 m0, s49, 24576
    s_add_u32 s51, s50, 0
    buffer_load_dwordx4 v2, s[8:11], s51 offen nt lds
    buffer_load_dwordx4 v3, s[8:11], s51 offen offset:1024 nt lds
    buffer_load_dwordx4 v4, s[8:11], s51 offen offset:2048 nt lds
    buffer_load_dwordx4 v5, s[8:11], s51 offen offset:3072 nt lds
    v_mfma_f32_16x16x32_bf16 v[160:163], v[192:195], v[26:29], 0
    v_mfma_f32_16x16x32_bf16 v[164:167], v[196:199], v[26:29], 0
    v_mfma_f32_16x16x32_bf16 v[168:171], v[200:203], v[26:29], 0
    v_mfma_f32_16x16x32_bf16 v[172:175], v[204:207], v[26:29], 0
    v_mfma_f32_16x16x32_bf16 v[176:179], v[208:211], v[26:29], 0
    v_mfma_f32_16x16x32_bf16 v[180:183], v[212:215], v[26:29], 0
    v_mfma_f32_16x16x32_bf16 v[184:187], v[216:219], v[26:29], 0
    v_mfma_f32_16x16x32_bf16 v[188:191], v[220:223], v[26:29], 0
    s_mov_b64 s[70:71], exec
    s_mov_b32 exec_lo, 0x00030003
    s_mov_b32 exec_hi, 0x00030003
    ds_write_b128 v56, v[160:163] offset:4096
    ds_write_b128 v56, v[164:167] offset:4160
    ds_write_b128 v56, v[168:171] offset:4224
    ds_write_b128 v56, v[172:175] offset:4288
    ds_write_b128 v56, v[176:179] offset:4352
    ds_write_b128 v56, v[180:183] offset:4416
    ds_write_b128 v56, v[184:187] offset:4480
    ds_write_b128 v56, v[188:191] offset:4544
    s_mov_b64 exec, s[70:71]
    s_waitcnt vmcnt(4)
    ds_read_b64_tr_b16 v[192:193], v12 offset:16384
    ds_read_b64_tr_b16 v[194:195], v12 offset:20480
    ds_read_b64_tr_b16 v[196:197], v13 offset:16384
    ds_read_b64_tr_b16 v[198:199], v13 offset:20480
    ds_read_b64_tr_b16 v[200:201], v14 offset:16384
    ds_read_b64_tr_b16 v[202:203], v14 offset:20480
    ds_read_b64_tr_b16 v[204:205], v15 offset:16384
    ds_read_b64_tr_b16 v[206:207], v15 offset:20480
    ds_read_b64_tr_b16 v[208:209], v16 offset:16384
    ds_read_b64_tr_b16 v[210:211], v16 offset:20480
    ds_read_b64_tr_b16 v[212:213], v17 offset:16384
    ds_read_b64_tr_b16 v[214:215], v17 offset:20480
    ds_read_b64_tr_b16 v[216:217], v18 offset:16384
    ds_read_b64_tr_b16 v[218:219], v18 offset:20480
    ds_read_b64_tr_b16 v[220:221], v19 offset:16384
    ds_read_b64_tr_b16 v[222:223], v19 offset:20480
    s_waitcnt lgkmcnt(0)
    v_and_b32 v61, 31, v1
    v_lshrrev_b32 v232, 2, v61
    v_and_b32 v61, 3, v61
    v_lshlrev_b32 v61, 4, v61
    v_lshl_add_u32 v61, v232, 10, v61
    buffer_load_dwordx4 v[64:67], v61, s[36:39], s73 offen sc1
    s_add_u32 m0, s49, 28672
    s_add_u32 s51, s50, 4096
    buffer_load_dwordx4 v2, s[8:11], s51 offen nt lds
    buffer_load_dwordx4 v3, s[8:11], s51 offen offset:1024 nt lds
    buffer_load_dwordx4 v4, s[8:11], s51 offen offset:2048 nt lds
    buffer_load_dwordx4 v5, s[8:11], s51 offen offset:3072 nt lds
    s_add_u32 m0, s49, 0
    s_add_u32 s51, s50, 32768
    buffer_load_dwordx4 v2, s[8:11], s51 offen nt lds
    buffer_load_dwordx4 v3, s[8:11], s51 offen offset:1024 nt lds
    buffer_load_dwordx4 v4, s[8:11], s51 offen offset:2048 nt lds
    buffer_load_dwordx4 v5, s[8:11], s51 offen offset:3072 nt lds
    v_mfma_f32_16x16x32_bf16 v[160:163], v[192:195], v[26:29], 0
    v_mfma_f32_16x16x32_bf16 v[164:167], v[196:199], v[26:29], 0
    v_mfma_f32_16x16x32_bf16 v[168:171], v[200:203], v[26:29], 0
    v_mfma_f32_16x16x32_bf16 v[172:175], v[204:207], v[26:29], 0
    v_mfma_f32_16x16x32_bf16 v[176:179], v[208:211], v[26:29], 0
    v_mfma_f32_16x16x32_bf16 v[180:183], v[212:215], v[26:29], 0
    v_mfma_f32_16x16x32_bf16 v[184:187], v[216:219], v[26:29], 0
    v_mfma_f32_16x16x32_bf16 v[188:191], v[220:223], v[26:29], 0
    s_mov_b64 s[70:71], exec
    s_mov_b32 exec_lo, 0x00030003
    s_mov_b32 exec_hi, 0x00030003
    ds_write_b128 v56, v[160:163] offset:8192
    ds_write_b128 v56, v[164:167] offset:8256
    ds_write_b128 v56, v[168:171] offset:8320
    ds_write_b128 v56, v[172:175] offset:8384
    ds_write_b128 v56, v[176:179] offset:8448
    ds_write_b128 v56, v[180:183] offset:8512
    ds_write_b128 v56, v[184:187] offset:8576
    ds_write_b128 v56, v[188:191] offset:8640
    s_mov_b64 exec, s[70:71]
    s_waitcnt lgkmcnt(0)
    s_barrier
    s_lshr_b32 s90, s3, 1
    s_lshl_b32 s90, s90, 12
    s_and_b32 s91, s3, 1
    s_lshl_b32 s91, s91, 9
    s_add_u32 s90, s90, s91
    s_add_u32 s90, s90, 135168
    v_lshlrev_b32 v244, 3, v1
    v_add_u32 v244, s90, v244
    ds_read_b64 v[232:233], v244 offset:0
    ds_read_b64 v[234:235], v244 offset:1024
    ds_read_b64 v[236:237], v244 offset:2048
    ds_read_b64 v[238:239], v244 offset:3072
    v_lshlrev_b32 v245, 4, v224
    v_lshl_add_u32 v245, v225, 13, v245
    s_waitcnt lgkmcnt(0)
    v_pk_add_f32 v[232:233], v[232:233], v[234:235]
    v_pk_add_f32 v[236:237], v[236:237], v[238:239]
    v_pk_add_f32 v[232:233], v[232:233], v[236:237]
    v_mov_b32 v234, v233
    v_mov_b32 v233, v38
    v_mov_b32 v235, v38
    buffer_store_dwordx4 v[232:235], v245, s[36:39], s76 offen sc1
    s_add_u32 s83, s77, 4096
    s_waitcnt vmcnt(5)
    ds_read_b128 a[0:3], v8 offset:24576
    ds_read_b128 a[4:7], v9 offset:24576
    ds_read_b128 a[8:11], v10 offset:24576
    ds_read_b128 a[12:15], v11 offset:24576
    ds_read_b128 a[16:19], v8 offset:28672
    ds_read_b128 a[20:23], v9 offset:28672
    ds_read_b128 a[24:27], v10 offset:28672
    ds_read_b128 a[28:31], v11 offset:28672
    s_waitcnt lgkmcnt(0)
    s_add_u32 m0, s49, 4096
    s_add_u32 s51, s50, 36864
    buffer_load_dwordx4 v2, s[8:11], s51 offen nt lds
    buffer_load_dwordx4 v3, s[8:11], s51 offen offset:1024 nt lds
    buffer_load_dwordx4 v4, s[8:11], s51 offen offset:2048 nt lds
    buffer_load_dwordx4 v5, s[8:11], s51 offen offset:3072 nt lds
    s_add_u32 m0, s49, 8192
    s_add_u32 s51, s50, 65536
    buffer_load_dwordx4 v2, s[8:11], s51 offen nt lds
    buffer_load_dwordx4 v3, s[8:11], s51 offen offset:1024 nt lds
    buffer_load_dwordx4 v4, s[8:11], s51 offen offset:2048 nt lds
    buffer_load_dwordx4 v5, s[8:11], s51 offen offset:3072 nt lds
    s_waitcnt vmcnt(4)
    ds_read_b128 a[32:35], v8 offset:0
    ds_read_b128 a[36:39], v9 offset:0
    ds_read_b128 a[40:43], v10 offset:0
    ds_read_b128 a[44:47], v11 offset:0
    ds_read_b128 a[48:51], v8 offset:4096
    ds_read_b128 a[52:55], v9 offset:4096
    ds_read_b128 a[56:59], v10 offset:4096
    ds_read_b128 a[60:63], v11 offset:4096
    s_waitcnt lgkmcnt(0)
    buffer_load_dwordx4 v[72:75], v59, s[36:39], s77 offen sc1
    buffer_load_dwordx4 v[76:79], v59, s[36:39], s83 offen sc1
    s_add_u32 m0, s49, 12288
    s_add_u32 s51, s50, 69632
    buffer_load_dwordx4 v2, s[8:11], s51 offen nt lds
    buffer_load_dwordx4 v3, s[8:11], s51 offen offset:1024 nt lds
    buffer_load_dwordx4 v4, s[8:11], s51 offen offset:2048 nt lds
    buffer_load_dwordx4 v5, s[8:11], s51 offen offset:3072 nt lds
    s_add_u32 m0, s49, 16384
    s_add_u32 s51, s50, 98304
    buffer_load_dwordx4 v2, s[8:11], s51 offen nt lds
    buffer_load_dwordx4 v3, s[8:11], s51 offen offset:1024 nt lds
    buffer_load_dwordx4 v4, s[8:11], s51 offen offset:2048 nt lds
    buffer_load_dwordx4 v5, s[8:11], s51 offen offset:3072 nt lds
    s_waitcnt vmcnt(4)
    ds_read_b128 a[64:67], v8 offset:8192
    ds_read_b128 a[68:71], v9 offset:8192
    ds_read_b128 a[72:75], v10 offset:8192
    ds_read_b128 a[76:79], v11 offset:8192
    ds_read_b128 a[80:83], v8 offset:12288
    ds_read_b128 a[84:87], v9 offset:12288
    ds_read_b128 a[88:91], v10 offset:12288
    ds_read_b128 a[92:95], v11 offset:12288
    s_waitcnt lgkmcnt(0)
    v_min_u32 v232, v65, v67
    v_max_u32 v233, v65, v67
    v_xor_b32 v232, s48, v232
    v_xor_b32 v233, s48, v233
    v_or_b32 v232, v232, v233
    v_cmp_ne_u32 vcc, 0, v232
    s_cbranch_vccnz SLOW0
BACK0:
    v_add_f32_dpp v64, v64, v64 row_ror:4 row_mask:0xf bank_mask:0xf
    s_nop 1
    v_add_f32_dpp v64, v64, v64 row_ror:8 row_mask:0xf bank_mask:0xf
    v_mov_b32 v232, v64
    s_nop 1
    v_permlane16_swap_b32 v64, v232
    v_add_f32 v64, v64, v232
    v_add_f32_dpp v66, v66, v66 row_ror:4 row_mask:0xf bank_mask:0xf
    s_nop 1
    v_add_f32_dpp v66, v66, v66 row_ror:8 row_mask:0xf bank_mask:0xf
    v_mov_b32 v232, v66
    s_nop 1
    v_permlane16_swap_b32 v66, v232
    v_add_f32 v66, v66, v232
    v_cvt_pk_bf16_f32 v232, v64, v66
    v_mov_b32 v233, v38
    v_lshlrev_b32 v234, 3, v1
    v_mov_b32 v235, 2146435072
    v_cmp_gt_u32 vcc, 4, v1
    s_nop 1
    v_cndmask_b32 v234, v235, v234, vcc
    buffer_store_dwordx2 v[232:233], v234, s[36:39], s74 offen sc1
    s_add_u32 m0, s49, 20480
    s_add_u32 s51, s50, 102400
    buffer_load_dwordx4 v2, s[8:11], s51 offen nt lds
    buffer_load_dwordx4 v3, s[8:11], s51 offen offset:1024 nt lds
    buffer_load_dwordx4 v4, s[8:11], s51 offen offset:2048 nt lds
    buffer_load_dwordx4 v5, s[8:11], s51 offen offset:3072 nt lds
    s_add_u32 m0, s49, 24576
    s_add_u32 s51, s50, 131072
    buffer_load_dwordx4 v2, s[8:11], s51 offen nt lds
    buffer_load_dwordx4 v3, s[8:11], s51 offen offset:1024 nt lds
    buffer_load_dwordx4 v4, s[8:11], s51 offen offset:2048 nt lds
    buffer_load_dwordx4 v5, s[8:11], s51 offen offset:3072 nt lds
    s_waitcnt vmcnt(4)
    ds_read_b128 a[96:99], v8 offset:16384
    ds_read_b128 a[100:103], v9 offset:16384
    ds_read_b128 a[104:107], v10 offset:16384
    ds_read_b128 a[108:111], v11 offset:16384
    ds_read_b128 a[112:115], v8 offset:20480
    ds_read_b128 a[116:119], v9 offset:20480
    ds_read_b128 a[120:123], v10 offset:20480
    ds_read_b128 a[124:127], v11 offset:20480
    s_waitcnt lgkmcnt(0)
    s_add_u32 m0, s49, 28672
    s_add_u32 s51, s50, 135168
    buffer_load_dwordx4 v2, s[8:11], s51 offen nt lds
    buffer_load_dwordx4 v3, s[8:11], s51 offen offset:1024 nt lds
    buffer_load_dwordx4 v4, s[8:11], s51 offen offset:2048 nt lds
    buffer_load_dwordx4 v5, s[8:11], s51 offen offset:3072 nt lds
    s_add_u32 m0, s49, 0
    s_add_u32 s51, s50, 163840
    buffer_load_dwordx4 v2, s[8:11], s51 offen nt lds
    buffer_load_dwordx4 v3, s[8:11], s51 offen offset:1024 nt lds
    buffer_load_dwordx4 v4, s[8:11], s51 offen offset:2048 nt lds
    buffer_load_dwordx4 v5, s[8:11], s51 offen offset:3072 nt lds
    s_waitcnt vmcnt(4)
    ds_read_b128 a[128:131], v8 offset:24576
    ds_read_b128 a[132:135], v9 offset:24576
    ds_read_b128 a[136:139], v10 offset:24576
    ds_read_b128 a[140:143], v11 offset:24576
    ds_read_b128 a[144:147], v8 offset:28672
    ds_read_b128 a[148:151], v9 offset:28672
    ds_read_b128 a[152:155], v10 offset:28672
    ds_read_b128 a[156:159], v11 offset:28672
    s_waitcnt lgkmcnt(0)
    buffer_load_dwordx4 v[80:83], v59, s[36:39], s75 offen sc1
    s_add_u32 m0, s49, 4096
    s_add_u32 s51, s50, 167936
    buffer_load_dwordx4 v2, s[8:11], s51 offen nt lds
    buffer_load_dwordx4 v3, s[8:11], s51 offen offset:1024 nt lds
    buffer_load_dwordx4 v4, s[8:11], s51 offen offset:2048 nt lds
    buffer_load_dwordx4 v5, s[8:11], s51 offen offset:3072 nt lds
    s_add_u32 m0, s49, 8192
    s_add_u32 s51, s50, 196608
    buffer_load_dwordx4 v2, s[8:11], s51 offen nt lds
    buffer_load_dwordx4 v3, s[8:11], s51 offen offset:1024 nt lds
    buffer_load_dwordx4 v4, s[8:11], s51 offen offset:2048 nt lds
    buffer_load_dwordx4 v5, s[8:11], s51 offen offset:3072 nt lds
    s_waitcnt vmcnt(4)
    ds_read_b128 a[160:163], v8 offset:0
    ds_read_b128 a[164:167], v9 offset:0
    ds_read_b128 a[168:171], v10 offset:0
    ds_read_b128 a[172:175], v11 offset:0
    ds_read_b128 a[176:179], v8 offset:4096
    ds_read_b128 a[180:183], v9 offset:4096
    ds_read_b128 a[184:187], v10 offset:4096
    ds_read_b128 a[188:191], v11 offset:4096
    s_waitcnt lgkmcnt(0)
    s_add_u32 m0, s49, 12288
    s_add_u32 s51, s50, 200704
    buffer_load_dwordx4 v2, s[8:11], s51 offen nt lds
    buffer_load_dwordx4 v3, s[8:11], s51 offen offset:1024 nt lds
    buffer_load_dwordx4 v4, s[8:11], s51 offen offset:2048 nt lds
    buffer_load_dwordx4 v5, s[8:11], s51 offen offset:3072 nt lds
    s_add_u32 m0, s49, 16384
    s_add_u32 s51, s50, 229376
    buffer_load_dwordx4 v2, s[8:11], s51 offen nt lds
    buffer_load_dwordx4 v3, s[8:11], s51 offen offset:1024 nt lds
    buffer_load_dwordx4 v4, s[8:11], s51 offen offset:2048 nt lds
    buffer_load_dwordx4 v5, s[8:11], s51 offen offset:3072 nt lds
    s_waitcnt vmcnt(4)
    ds_read_b128 a[192:195], v8 offset:8192
    ds_read_b128 a[196:199], v9 offset:8192
    ds_read_b128 a[200:203], v10 offset:8192
    ds_read_b128 a[204:207], v11 offset:8192
    ds_read_b128 a[208:211], v8 offset:12288
    ds_read_b128 a[212:215], v9 offset:12288
    ds_read_b128 a[216:219], v10 offset:12288
    ds_read_b128 a[220:223], v11 offset:12288
    s_waitcnt lgkmcnt(0)
    s_add_u32 m0, s49, 20480
    s_add_u32 s51, s50, 233472
    buffer_load_dwordx4 v2, s[8:11], s51 offen nt lds
    buffer_load_dwordx4 v3, s[8:11], s51 offen offset:1024 nt lds
    buffer_load_dwordx4 v4, s[8:11], s51 offen offset:2048 nt lds
    buffer_load_dwordx4 v5, s[8:11], s51 offen offset:3072 nt lds
    s_add_u32 m0, s49, 24576
    s_add_u32 s51, s50, 0
    buffer_load_dwordx4 v6, s[12:15], s51 offen nt lds
    buffer_load_dwordx4 v7, s[12:15], s51 offen offset:1024 nt lds
    buffer_load_dwordx4 v6, s[12:15], s51 offen offset:2048 nt lds
    buffer_load_dwordx4 v7, s[12:15], s51 offen offset:3072 nt lds
    s_waitcnt vmcnt(4)
    ds_read_b128 a[224:227], v8 offset:16384
    ds_read_b128 a[228:231], v9 offset:16384
    ds_read_b128 a[232:235], v10 offset:16384
    ds_read_b128 a[236:239], v11 offset:16384
    ds_read_b128 a[240:243], v8 offset:20480
    ds_read_b128 a[244:247], v9 offset:20480
    ds_read_b128 a[248:251], v10 offset:20480
    ds_read_b128 a[252:255], v11 offset:20480
    s_waitcnt lgkmcnt(0)
    s_add_u32 m0, s49, 28672
    s_add_u32 s51, s50, 4096
    buffer_load_dwordx4 v6, s[12:15], s51 offen nt lds
    buffer_load_dwordx4 v7, s[12:15], s51 offen offset:1024 nt lds
    buffer_load_dwordx4 v6, s[12:15], s51 offen offset:2048 nt lds
    buffer_load_dwordx4 v7, s[12:15], s51 offen offset:3072 nt lds
    s_add_u32 m0, s49, 0
    s_add_u32 s51, s50, 32768
    buffer_load_dwordx4 v6, s[12:15], s51 offen nt lds
    buffer_load_dwordx4 v7, s[12:15], s51 offen offset:1024 nt lds
    buffer_load_dwordx4 v6, s[12:15], s51 offen offset:2048 nt lds
    buffer_load_dwordx4 v7, s[12:15], s51 offen offset:3072 nt lds
    v_min3_u32 v232, v73, v75, v77
    v_min3_u32 v232, v232, v79, v81
    v_min_u32 v232, v232, v83
    v_max3_u32 v233, v73, v75, v77
    v_max3_u32 v233, v233, v79, v81
    v_max_u32 v233, v233, v83
    v_xor_b32 v232, s48, v232
    v_xor_b32 v233, s48, v233
    v_or_b32 v232, v232, v233
    v_cmp_ne_u32 vcc, 0, v232
    s_cbranch_vccnz SLOW1
BACK1:
    v_lshrrev_b32 v232, 5, v0
    v_mul_u32_u24 v232, 272, v232
    v_and_b32 v233, 31, v0
    v_lshl_add_u32 v232, v233, 3, v232
    v_add_u32 v232, 143360, v232
    v_mov_b32 v81, v82
    ds_write_b64 v232, v[80:81]
    v_lshrrev_b32 v234, 4, v0
    v_mul_u32_u24 v234, 272, v234
    v_lshl_add_u32 v234, v224, 3, v234
    v_add_u32 v234, 145664, v234
    v_mov_b32 v73, v74
    ds_write_b64 v234, v[72:73] offset:0
    v_mov_b32 v77, v78
    ds_write_b64 v234, v[76:77] offset:128
    s_waitcnt lgkmcnt(0)
    s_barrier
    v_and_b32 v232, 7, v224
    v_mul_u32_u24 v232, 272, v232
    v_lshl_add_u32 v232, v225, 4, v232
    v_add_u32 v232, 143360, v232
    ds_read_b128 v[40:43], v232 offset:0
    ds_read_b128 v[44:47], v232 offset:64
    ds_read_b128 v[48:51], v232 offset:128
    ds_read_b128 v[52:55], v232 offset:192
    s_waitcnt lgkmcnt(0)
    v_mfma_f32_16x16x32_bf16 v[64:67], a[0:3], v[40:43], 0
    v_mfma_f32_16x16x32_bf16 v[68:71], a[16:19], v[40:43], 0
    v_mfma_f32_16x16x32_bf16 v[72:75], a[32:35], v[40:43], 0
    v_mfma_f32_16x16x32_bf16 v[76:79], a[48:51], v[40:43], 0
    v_mfma_f32_16x16x32_bf16 v[80:83], a[64:67], v[40:43], 0
    v_mfma_f32_16x16x32_bf16 v[84:87], a[80:83], v[40:43], 0
    v_mfma_f32_16x16x32_bf16 v[88:91], a[96:99], v[40:43], 0
    v_mfma_f32_16x16x32_bf16 v[92:95], a[112:115], v[40:43], 0
    v_mfma_f32_16x16x32_bf16 v[96:99], a[128:131], v[40:43], 0
    v_mfma_f32_16x16x32_bf16 v[100:103], a[144:147], v[40:43], 0
    v_mfma_f32_16x16x32_bf16 v[104:107], a[160:163], v[40:43], 0
    v_mfma_f32_16x16x32_bf16 v[108:111], a[176:179], v[40:43], 0
    v_mfma_f32_16x16x32_bf16 v[112:115], a[192:195], v[40:43], 0
    v_mfma_f32_16x16x32_bf16 v[116:119], a[208:211], v[40:43], 0
    v_mfma_f32_16x16x32_bf16 v[120:123], a[224:227], v[40:43], 0
    v_mfma_f32_16x16x32_bf16 v[124:127], a[240:243], v[40:43], 0
    v_mfma_f32_16x16x32_bf16 v[64:67], a[4:7], v[44:47], v[64:67]
    v_mfma_f32_16x16x32_bf16 v[68:71], a[20:23], v[44:47], v[68:71]
    v_mfma_f32_16x16x32_bf16 v[72:75], a[36:39], v[44:47], v[72:75]
    v_mfma_f32_16x16x32_bf16 v[76:79], a[52:55], v[44:47], v[76:79]
    v_mfma_f32_16x16x32_bf16 v[80:83], a[68:71], v[44:47], v[80:83]
    v_mfma_f32_16x16x32_bf16 v[84:87], a[84:87], v[44:47], v[84:87]
    v_mfma_f32_16x16x32_bf16 v[88:91], a[100:103], v[44:47], v[88:91]
    v_mfma_f32_16x16x32_bf16 v[92:95], a[116:119], v[44:47], v[92:95]
    v_mfma_f32_16x16x32_bf16 v[96:99], a[132:135], v[44:47], v[96:99]
    v_mfma_f32_16x16x32_bf16 v[100:103], a[148:151], v[44:47], v[100:103]
    v_mfma_f32_16x16x32_bf16 v[104:107], a[164:167], v[44:47], v[104:107]
    v_mfma_f32_16x16x32_bf16 v[108:111], a[180:183], v[44:47], v[108:111]
    v_mfma_f32_16x16x32_bf16 v[112:115], a[196:199], v[44:47], v[112:115]
    v_mfma_f32_16x16x32_bf16 v[116:119], a[212:215], v[44:47], v[116:119]
    v_mfma_f32_16x16x32_bf16 v[120:123], a[228:231], v[44:47], v[120:123]
    v_mfma_f32_16x16x32_bf16 v[124:127], a[244:247], v[44:47], v[124:127]
    v_mfma_f32_16x16x32_bf16 v[64:67], a[8:11], v[48:51], v[64:67]
    v_mfma_f32_16x16x32_bf16 v[68:71], a[24:27], v[48:51], v[68:71]
    v_mfma_f32_16x16x32_bf16 v[72:75], a[40:43], v[48:51], v[72:75]
    v_mfma_f32_16x16x32_bf16 v[76:79], a[56:59], v[48:51], v[76:79]
    v_mfma_f32_16x16x32_bf16 v[80:83], a[72:75], v[48:51], v[80:83]
    v_mfma_f32_16x16x32_bf16 v[84:87], a[88:91], v[48:51], v[84:87]
    v_mfma_f32_16x16x32_bf16 v[88:91], a[104:107], v[48:51], v[88:91]
    v_mfma_f32_16x16x32_bf16 v[92:95], a[120:123], v[48:51], v[92:95]
    v_mfma_f32_16x16x32_bf16 v[96:99], a[136:139], v[48:51], v[96:99]
    v_mfma_f32_16x16x32_bf16 v[100:103], a[152:155], v[48:51], v[100:103]
    v_mfma_f32_16x16x32_bf16 v[104:107], a[168:171], v[48:51], v[104:107]
    v_mfma_f32_16x16x32_bf16 v[108:111], a[184:187], v[48:51], v[108:111]
    v_mfma_f32_16x16x32_bf16 v[112:115], a[200:203], v[48:51], v[112:115]
    v_mfma_f32_16x16x32_bf16 v[116:119], a[216:219], v[48:51], v[116:119]
    v_mfma_f32_16x16x32_bf16 v[120:123], a[232:235], v[48:51], v[120:123]
    v_mfma_f32_16x16x32_bf16 v[124:127], a[248:251], v[48:51], v[124:127]
    v_mfma_f32_16x16x32_bf16 v[64:67], a[12:15], v[52:55], v[64:67]
    v_mfma_f32_16x16x32_bf16 v[68:71], a[28:31], v[52:55], v[68:71]
    v_mfma_f32_16x16x32_bf16 v[72:75], a[44:47], v[52:55], v[72:75]
    v_mfma_f32_16x16x32_bf16 v[76:79], a[60:63], v[52:55], v[76:79]
    v_mfma_f32_16x16x32_bf16 v[80:83], a[76:79], v[52:55], v[80:83]
    v_mfma_f32_16x16x32_bf16 v[84:87], a[92:95], v[52:55], v[84:87]
    v_mfma_f32_16x16x32_bf16 v[88:91], a[108:111], v[52:55], v[88:91]
    v_mfma_f32_16x16x32_bf16 v[92:95], a[124:127], v[52:55], v[92:95]
    v_mfma_f32_16x16x32_bf16 v[96:99], a[140:143], v[52:55], v[96:99]
    v_mfma_f32_16x16x32_bf16 v[100:103], a[156:159], v[52:55], v[100:103]
    v_mfma_f32_16x16x32_bf16 v[104:107], a[172:175], v[52:55], v[104:107]
    v_mfma_f32_16x16x32_bf16 v[108:111], a[188:191], v[52:55], v[108:111]
    v_mfma_f32_16x16x32_bf16 v[112:115], a[204:207], v[52:55], v[112:115]
    v_mfma_f32_16x16x32_bf16 v[116:119], a[220:223], v[52:55], v[116:119]
    v_mfma_f32_16x16x32_bf16 v[120:123], a[236:239], v[52:55], v[120:123]
    v_mfma_f32_16x16x32_bf16 v[124:127], a[252:255], v[52:55], v[124:127]
    s_add_u32 m0, s49, 4096
    s_add_u32 s51, s50, 36864
    buffer_load_dwordx4 v6, s[12:15], s51 offen nt lds
    buffer_load_dwordx4 v7, s[12:15], s51 offen offset:1024 nt lds
    buffer_load_dwordx4 v6, s[12:15], s51 offen offset:2048 nt lds
    buffer_load_dwordx4 v7, s[12:15], s51 offen offset:3072 nt lds
    s_add_u32 m0, s49, 8192
    s_add_u32 s51, s50, 65536
    buffer_load_dwordx4 v6, s[12:15], s51 offen nt lds
    buffer_load_dwordx4 v7, s[12:15], s51 offen offset:1024 nt lds
    buffer_load_dwordx4 v6, s[12:15], s51 offen offset:2048 nt lds
    buffer_load_dwordx4 v7, s[12:15], s51 offen offset:3072 nt lds
    s_add_u32 m0, s49, 12288
    s_add_u32 s51, s50, 69632
    buffer_load_dwordx4 v6, s[12:15], s51 offen nt lds
    buffer_load_dwordx4 v7, s[12:15], s51 offen offset:1024 nt lds
    buffer_load_dwordx4 v6, s[12:15], s51 offen offset:2048 nt lds
    buffer_load_dwordx4 v7, s[12:15], s51 offen offset:3072 nt lds
    v_cvt_pk_bf16_f32 v192, v64, v65
    v_cvt_pk_bf16_f32 v193, v66, v67
    v_cvt_pk_bf16_f32 v194, v68, v69
    v_cvt_pk_bf16_f32 v195, v70, v71
    v_cvt_pk_bf16_f32 v196, v72, v73
    v_cvt_pk_bf16_f32 v197, v74, v75
    v_cvt_pk_bf16_f32 v198, v76, v77
    v_cvt_pk_bf16_f32 v199, v78, v79
    v_cvt_pk_bf16_f32 v200, v80, v81
    v_cvt_pk_bf16_f32 v201, v82, v83
    v_cvt_pk_bf16_f32 v202, v84, v85
    v_cvt_pk_bf16_f32 v203, v86, v87
    v_cvt_pk_bf16_f32 v204, v88, v89
    v_cvt_pk_bf16_f32 v205, v90, v91
    v_cvt_pk_bf16_f32 v206, v92, v93
    v_cvt_pk_bf16_f32 v207, v94, v95
    v_cvt_pk_bf16_f32 v208, v96, v97
    v_cvt_pk_bf16_f32 v209, v98, v99
    v_cvt_pk_bf16_f32 v210, v100, v101
    v_cvt_pk_bf16_f32 v211, v102, v103
    v_cvt_pk_bf16_f32 v212, v104, v105
    v_cvt_pk_bf16_f32 v213, v106, v107
    v_cvt_pk_bf16_f32 v214, v108, v109
    v_cvt_pk_bf16_f32 v215, v110, v111
    v_cvt_pk_bf16_f32 v216, v112, v113
    v_cvt_pk_bf16_f32 v217, v114, v115
    v_cvt_pk_bf16_f32 v218, v116, v117
    v_cvt_pk_bf16_f32 v219, v118, v119
    v_cvt_pk_bf16_f32 v220, v120, v121
    v_cvt_pk_bf16_f32 v221, v122, v123
    v_cvt_pk_bf16_f32 v222, v124, v125
    v_cvt_pk_bf16_f32 v223, v126, v127
    v_and_b32 v65, s68, v192
    v_lshlrev_b32 v64, 16, v192
    v_and_b32 v67, s68, v193
    v_lshlrev_b32 v66, 16, v193
    v_and_b32 v69, s68, v194
    v_lshlrev_b32 v68, 16, v194
    v_and_b32 v71, s68, v195
    v_lshlrev_b32 v70, 16, v195
    v_and_b32 v73, s68, v196
    v_lshlrev_b32 v72, 16, v196
    v_and_b32 v75, s68, v197
    v_lshlrev_b32 v74, 16, v197
    v_and_b32 v77, s68, v198
    v_lshlrev_b32 v76, 16, v198
    v_and_b32 v79, s68, v199
    v_lshlrev_b32 v78, 16, v199
    v_and_b32 v81, s68, v200
    v_lshlrev_b32 v80, 16, v200
    v_and_b32 v83, s68, v201
    v_lshlrev_b32 v82, 16, v201
    v_and_b32 v85, s68, v202
    v_lshlrev_b32 v84, 16, v202
    v_and_b32 v87, s68, v203
    v_lshlrev_b32 v86, 16, v203
    v_and_b32 v89, s68, v204
    v_lshlrev_b32 v88, 16, v204
    v_and_b32 v91, s68, v205
    v_lshlrev_b32 v90, 16, v205
    v_and_b32 v93, s68, v206
    v_lshlrev_b32 v92, 16, v206
    v_and_b32 v95, s68, v207
    v_lshlrev_b32 v94, 16, v207
    v_and_b32 v97, s68, v208
    v_lshlrev_b32 v96, 16, v208
    v_and_b32 v99, s68, v209
    v_lshlrev_b32 v98, 16, v209
    v_and_b32 v101, s68, v210
    v_lshlrev_b32 v100, 16, v210
    v_and_b32 v103, s68, v211
    v_lshlrev_b32 v102, 16, v211
    v_and_b32 v105, s68, v212
    v_lshlrev_b32 v104, 16, v212
    v_and_b32 v107, s68, v213
    v_lshlrev_b32 v106, 16, v213
    v_and_b32 v109, s68, v214
    v_lshlrev_b32 v108, 16, v214
    v_and_b32 v111, s68, v215
    v_lshlrev_b32 v110, 16, v215
    v_and_b32 v113, s68, v216
    v_lshlrev_b32 v112, 16, v216
    v_and_b32 v115, s68, v217
    v_lshlrev_b32 v114, 16, v217
    v_and_b32 v117, s68, v218
    v_lshlrev_b32 v116, 16, v218
    v_and_b32 v119, s68, v219
    v_lshlrev_b32 v118, 16, v219
    v_and_b32 v121, s68, v220
    v_lshlrev_b32 v120, 16, v220
    v_and_b32 v123, s68, v221
    v_lshlrev_b32 v122, 16, v221
    v_and_b32 v125, s68, v222
    v_lshlrev_b32 v124, 16, v222
    v_and_b32 v127, s68, v223
    v_lshlrev_b32 v126, 16, v223
    v_pk_mul_f32 v[64:65], v[64:65], s[64:65]
    v_pk_mul_f32 v[66:67], v[66:67], s[64:65]
    v_pk_mul_f32 v[68:69], v[68:69], s[64:65]
    v_pk_mul_f32 v[70:71], v[70:71], s[64:65]
    v_pk_mul_f32 v[72:73], v[72:73], s[64:65]
    v_pk_mul_f32 v[74:75], v[74:75], s[64:65]
    v_pk_mul_f32 v[76:77], v[76:77], s[64:65]
    v_pk_mul_f32 v[78:79], v[78:79], s[64:65]
    v_pk_mul_f32 v[80:81], v[80:81], s[64:65]
    v_pk_mul_f32 v[82:83], v[82:83], s[64:65]
    v_pk_mul_f32 v[84:85], v[84:85], s[64:65]
    v_pk_mul_f32 v[86:87], v[86:87], s[64:65]
    v_pk_mul_f32 v[88:89], v[88:89], s[64:65]
    v_pk_mul_f32 v[90:91], v[90:91], s[64:65]
    v_pk_mul_f32 v[92:93], v[92:93], s[64:65]
    v_pk_mul_f32 v[94:95], v[94:95], s[64:65]
    v_pk_mul_f32 v[96:97], v[96:97], s[64:65]
    v_pk_mul_f32 v[98:99], v[98:99], s[64:65]
    v_pk_mul_f32 v[100:101], v[100:101], s[64:65]
    v_pk_mul_f32 v[102:103], v[102:103], s[64:65]
    v_pk_mul_f32 v[104:105], v[104:105], s[64:65]
    v_pk_mul_f32 v[106:107], v[106:107], s[64:65]
    v_pk_mul_f32 v[108:109], v[108:109], s[64:65]
    v_pk_mul_f32 v[110:111], v[110:111], s[64:65]
    v_pk_mul_f32 v[112:113], v[112:113], s[64:65]
    v_pk_mul_f32 v[114:115], v[114:115], s[64:65]
    v_pk_mul_f32 v[116:117], v[116:117], s[64:65]
    v_pk_mul_f32 v[118:119], v[118:119], s[64:65]
    v_pk_mul_f32 v[120:121], v[120:121], s[64:65]
    v_pk_mul_f32 v[122:123], v[122:123], s[64:65]
    v_pk_mul_f32 v[124:125], v[124:125], s[64:65]
    v_pk_mul_f32 v[126:127], v[126:127], s[64:65]
    v_cvt_pk_bf16_f32 v192, v64, v65
    v_cvt_pk_bf16_f32 v193, v66, v67
    v_cvt_pk_bf16_f32 v194, v68, v69
    v_cvt_pk_bf16_f32 v195, v70, v71
    v_cvt_pk_bf16_f32 v196, v72, v73
    v_cvt_pk_bf16_f32 v197, v74, v75
    v_cvt_pk_bf16_f32 v198, v76, v77
    v_cvt_pk_bf16_f32 v199, v78, v79
    v_cvt_pk_bf16_f32 v200, v80, v81
    v_cvt_pk_bf16_f32 v201, v82, v83
    v_cvt_pk_bf16_f32 v202, v84, v85
    v_cvt_pk_bf16_f32 v203, v86, v87
    v_cvt_pk_bf16_f32 v204, v88, v89
    v_cvt_pk_bf16_f32 v205, v90, v91
    v_cvt_pk_bf16_f32 v206, v92, v93
    v_cvt_pk_bf16_f32 v207, v94, v95
    v_cvt_pk_bf16_f32 v208, v96, v97
    v_cvt_pk_bf16_f32 v209, v98, v99
    v_cvt_pk_bf16_f32 v210, v100, v101
    v_cvt_pk_bf16_f32 v211, v102, v103
    v_cvt_pk_bf16_f32 v212, v104, v105
    v_cvt_pk_bf16_f32 v213, v106, v107
    v_cvt_pk_bf16_f32 v214, v108, v109
    v_cvt_pk_bf16_f32 v215, v110, v111
    v_cvt_pk_bf16_f32 v216, v112, v113
    v_cvt_pk_bf16_f32 v217, v114, v115
    v_cvt_pk_bf16_f32 v218, v116, v117
    v_cvt_pk_bf16_f32 v219, v118, v119
    v_cvt_pk_bf16_f32 v220, v120, v121
    v_cvt_pk_bf16_f32 v221, v122, v123
    v_cvt_pk_bf16_f32 v222, v124, v125
    v_cvt_pk_bf16_f32 v223, v126, v127
    v_and_b32 v65, s68, v192
    v_lshlrev_b32 v64, 16, v192
    v_and_b32 v67, s68, v193
    v_lshlrev_b32 v66, 16, v193
    v_and_b32 v69, s68, v194
    v_lshlrev_b32 v68, 16, v194
    v_and_b32 v71, s68, v195
    v_lshlrev_b32 v70, 16, v195
    v_and_b32 v73, s68, v196
    v_lshlrev_b32 v72, 16, v196
    v_and_b32 v75, s68, v197
    v_lshlrev_b32 v74, 16, v197
    v_and_b32 v77, s68, v198
    v_lshlrev_b32 v76, 16, v198
    v_and_b32 v79, s68, v199
    v_lshlrev_b32 v78, 16, v199
    v_and_b32 v81, s68, v200
    v_lshlrev_b32 v80, 16, v200
    v_and_b32 v83, s68, v201
    v_lshlrev_b32 v82, 16, v201
    v_and_b32 v85, s68, v202
    v_lshlrev_b32 v84, 16, v202
    v_and_b32 v87, s68, v203
    v_lshlrev_b32 v86, 16, v203
    v_and_b32 v89, s68, v204
    v_lshlrev_b32 v88, 16, v204
    v_and_b32 v91, s68, v205
    v_lshlrev_b32 v90, 16, v205
    v_and_b32 v93, s68, v206
    v_lshlrev_b32 v92, 16, v206
    v_and_b32 v95, s68, v207
    v_lshlrev_b32 v94, 16, v207
    v_and_b32 v97, s68, v208
    v_lshlrev_b32 v96, 16, v208
    v_and_b32 v99, s68, v209
    v_lshlrev_b32 v98, 16, v209
    v_and_b32 v101, s68, v210
    v_lshlrev_b32 v100, 16, v210
    v_and_b32 v103, s68, v211
    v_lshlrev_b32 v102, 16, v211
    v_and_b32 v105, s68, v212
    v_lshlrev_b32 v104, 16, v212
    v_and_b32 v107, s68, v213
    v_lshlrev_b32 v106, 16, v213
    v_and_b32 v109, s68, v214
    v_lshlrev_b32 v108, 16, v214
    v_and_b32 v111, s68, v215
    v_lshlrev_b32 v110, 16, v215
    v_and_b32 v113, s68, v216
    v_lshlrev_b32 v112, 16, v216
    v_and_b32 v115, s68, v217
    v_lshlrev_b32 v114, 16, v217
    v_and_b32 v117, s68, v218
    v_lshlrev_b32 v116, 16, v218
    v_and_b32 v119, s68, v219
    v_lshlrev_b32 v118, 16, v219
    v_and_b32 v121, s68, v220
    v_lshlrev_b32 v120, 16, v220
    v_and_b32 v123, s68, v221
    v_lshlrev_b32 v122, 16, v221
    v_and_b32 v125, s68, v222
    v_lshlrev_b32 v124, 16, v222
    v_and_b32 v127, s68, v223
    v_lshlrev_b32 v126, 16, v223
    v_max3_f32 v232, v64, v65, v66
    v_max3_f32 v233, v80, v81, v82
    v_max3_f32 v234, v96, v97, v98
    v_max3_f32 v235, v112, v113, v114
    v_max3_f32 v232, v232, v67, v68
    v_max3_f32 v233, v233, v83, v84
    v_max3_f32 v234, v234, v99, v100
    v_max3_f32 v235, v235, v115, v116
    v_max3_f32 v232, v232, v69, v70
    v_max3_f32 v233, v233, v85, v86
    v_max3_f32 v234, v234, v101, v102
    v_max3_f32 v235, v235, v117, v118
    v_max3_f32 v232, v232, v71, v72
    v_max3_f32 v233, v233, v87, v88
    v_max3_f32 v234, v234, v103, v104
    v_max3_f32 v235, v235, v119, v120
    v_max3_f32 v232, v232, v73, v74
    v_max3_f32 v233, v233, v89, v90
    v_max3_f32 v234, v234, v105, v106
    v_max3_f32 v235, v235, v121, v122
    v_max3_f32 v232, v232, v75, v76
    v_max3_f32 v233, v233, v91, v92
    v_max3_f32 v234, v234, v107, v108
    v_max3_f32 v235, v235, v123, v124
    v_max3_f32 v232, v232, v77, v78
    v_max3_f32 v233, v233, v93, v94
    v_max3_f32 v234, v234, v109, v110
    v_max3_f32 v235, v235, v125, v126
    v_max_f32 v232, v232, v79
    v_max_f32 v233, v233, v95
    v_max_f32 v234, v234, v111
    v_max_f32 v235, v235, v127
    v_max3_f32 v232, v232, v233, v234
    v_max_f32 v62, v232, v235
    v_mov_b32 v232, v62
    s_nop 1
    v_permlane32_swap_b32 v62, v232
    v_max_f32 v62, v62, v232
    v_mov_b32 v232, v62
    s_nop 1
    v_permlane16_swap_b32 v62, v232
    v_max_f32 v62, v62, v232
    v_mul_f32 v62, s66, v62
    v_sub_f32 v232, 0, v62
    v_mov_b32 v233, v232
    v_pk_fma_f32 v[64:65], v[64:65], s[66:67], v[232:233]
    v_pk_fma_f32 v[66:67], v[66:67], s[66:67], v[232:233]
    v_pk_fma_f32 v[68:69], v[68:69], s[66:67], v[232:233]
    v_pk_fma_f32 v[70:71], v[70:71], s[66:67], v[232:233]
    v_pk_fma_f32 v[72:73], v[72:73], s[66:67], v[232:233]
    v_pk_fma_f32 v[74:75], v[74:75], s[66:67], v[232:233]
    v_pk_fma_f32 v[76:77], v[76:77], s[66:67], v[232:233]
    v_pk_fma_f32 v[78:79], v[78:79], s[66:67], v[232:233]
    v_pk_fma_f32 v[80:81], v[80:81], s[66:67], v[232:233]
    v_pk_fma_f32 v[82:83], v[82:83], s[66:67], v[232:233]
    v_pk_fma_f32 v[84:85], v[84:85], s[66:67], v[232:233]
    v_pk_fma_f32 v[86:87], v[86:87], s[66:67], v[232:233]
    v_pk_fma_f32 v[88:89], v[88:89], s[66:67], v[232:233]
    v_pk_fma_f32 v[90:91], v[90:91], s[66:67], v[232:233]
    v_pk_fma_f32 v[92:93], v[92:93], s[66:67], v[232:233]
    v_pk_fma_f32 v[94:95], v[94:95], s[66:67], v[232:233]
    v_pk_fma_f32 v[96:97], v[96:97], s[66:67], v[232:233]
    v_pk_fma_f32 v[98:99], v[98:99], s[66:67], v[232:233]
    v_pk_fma_f32 v[100:101], v[100:101], s[66:67], v[232:233]
    v_pk_fma_f32 v[102:103], v[102:103], s[66:67], v[232:233]
    v_pk_fma_f32 v[104:105], v[104:105], s[66:67], v[232:233]
    v_pk_fma_f32 v[106:107], v[106:107], s[66:67], v[232:233]
    v_pk_fma_f32 v[108:109], v[108:109], s[66:67], v[232:233]
    v_pk_fma_f32 v[110:111], v[110:111], s[66:67], v[232:233]
    v_pk_fma_f32 v[112:113], v[112:113], s[66:67], v[232:233]
    v_pk_fma_f32 v[114:115], v[114:115], s[66:67], v[232:233]
    v_pk_fma_f32 v[116:117], v[116:117], s[66:67], v[232:233]
    v_pk_fma_f32 v[118:119], v[118:119], s[66:67], v[232:233]
    v_pk_fma_f32 v[120:121], v[120:121], s[66:67], v[232:233]
    v_pk_fma_f32 v[122:123], v[122:123], s[66:67], v[232:233]
    v_pk_fma_f32 v[124:125], v[124:125], s[66:67], v[232:233]
    v_pk_fma_f32 v[126:127], v[126:127], s[66:67], v[232:233]
    v_exp_f32 v64, v64
    v_exp_f32 v65, v65
    v_exp_f32 v66, v66
    v_exp_f32 v67, v67
    v_exp_f32 v68, v68
    v_exp_f32 v69, v69
    v_exp_f32 v70, v70
    v_exp_f32 v71, v71
    v_exp_f32 v72, v72
    v_exp_f32 v73, v73
    v_exp_f32 v74, v74
    v_exp_f32 v75, v75
    v_exp_f32 v76, v76
    v_exp_f32 v77, v77
    v_exp_f32 v78, v78
    v_exp_f32 v79, v79
    v_exp_f32 v80, v80
    v_exp_f32 v81, v81
    v_exp_f32 v82, v82
    v_exp_f32 v83, v83
    v_exp_f32 v84, v84
    v_exp_f32 v85, v85
    v_exp_f32 v86, v86
    v_exp_f32 v87, v87
    v_exp_f32 v88, v88
    v_exp_f32 v89, v89
    v_exp_f32 v90, v90
    v_exp_f32 v91, v91
    v_exp_f32 v92, v92
    v_exp_f32 v93, v93
    v_exp_f32 v94, v94
    v_exp_f32 v95, v95
    v_exp_f32 v96, v96
    v_exp_f32 v97, v97
    v_exp_f32 v98, v98
    v_exp_f32 v99, v99
    v_exp_f32 v100, v100
    v_exp_f32 v101, v101
    v_exp_f32 v102, v102
    v_exp_f32 v103, v103
    v_exp_f32 v104, v104
    v_exp_f32 v105, v105
    v_exp_f32 v106, v106
    v_exp_f32 v107, v107
    v_exp_f32 v108, v108
    v_exp_f32 v109, v109
    v_exp_f32 v110, v110
    v_exp_f32 v111, v111
    v_exp_f32 v112, v112
    v_exp_f32 v113, v113
    v_exp_f32 v114, v114
    v_exp_f32 v115, v115
    v_exp_f32 v116, v116
    v_exp_f32 v117, v117
    v_exp_f32 v118, v118
    v_exp_f32 v119, v119
    v_exp_f32 v120, v120
    v_exp_f32 v121, v121
    v_exp_f32 v122, v122
    v_exp_f32 v123, v123
    v_exp_f32 v124, v124
    v_exp_f32 v125, v125
    v_exp_f32 v126, v126
    v_exp_f32 v127, v127
    v_cvt_pk_bf16_f32 v128, v64, v65
    v_cvt_pk_bf16_f32 v129, v66, v67
    v_cvt_pk_bf16_f32 v130, v68, v69
    v_cvt_pk_bf16_f32 v131, v70, v71
    v_cvt_pk_bf16_f32 v132, v72, v73
    v_cvt_pk_bf16_f32 v133, v74, v75
    v_cvt_pk_bf16_f32 v134, v76, v77
    v_cvt_pk_bf16_f32 v135, v78, v79
    v_cvt_pk_bf16_f32 v136, v80, v81
    v_cvt_pk_bf16_f32 v137, v82, v83
    v_cvt_pk_bf16_f32 v138, v84, v85
    v_cvt_pk_bf16_f32 v139, v86, v87
    v_cvt_pk_bf16_f32 v140, v88, v89
    v_cvt_pk_bf16_f32 v141, v90, v91
    v_cvt_pk_bf16_f32 v142, v92, v93
    v_cvt_pk_bf16_f32 v143, v94, v95
    v_cvt_pk_bf16_f32 v144, v96, v97
    v_cvt_pk_bf16_f32 v145, v98, v99
    v_cvt_pk_bf16_f32 v146, v100, v101
    v_cvt_pk_bf16_f32 v147, v102, v103
    v_cvt_pk_bf16_f32 v148, v104, v105
    v_cvt_pk_bf16_f32 v149, v106, v107
    v_cvt_pk_bf16_f32 v150, v108, v109
    v_cvt_pk_bf16_f32 v151, v110, v111
    v_cvt_pk_bf16_f32 v152, v112, v113
    v_cvt_pk_bf16_f32 v153, v114, v115
    v_cvt_pk_bf16_f32 v154, v116, v117
    v_cvt_pk_bf16_f32 v155, v118, v119
    v_cvt_pk_bf16_f32 v156, v120, v121
    v_cvt_pk_bf16_f32 v157, v122, v123
    v_cvt_pk_bf16_f32 v158, v124, v125
    v_cvt_pk_bf16_f32 v159, v126, v127
    v_pk_add_f32 v[232:233], v[64:65], v[66:67]
    v_pk_add_f32 v[234:235], v[80:81], v[82:83]
    v_pk_add_f32 v[236:237], v[96:97], v[98:99]
    v_pk_add_f32 v[238:239], v[112:113], v[114:115]
    v_pk_add_f32 v[232:233], v[232:233], v[68:69]
    v_pk_add_f32 v[234:235], v[234:235], v[84:85]
    v_pk_add_f32 v[236:237], v[236:237], v[100:101]
    v_pk_add_f32 v[238:239], v[238:239], v[116:117]
    v_pk_add_f32 v[232:233], v[232:233], v[70:71]
    v_pk_add_f32 v[234:235], v[234:235], v[86:87]
    v_pk_add_f32 v[236:237], v[236:237], v[102:103]
    v_pk_add_f32 v[238:239], v[238:239], v[118:119]
    v_pk_add_f32 v[232:233], v[232:233], v[72:73]
    v_pk_add_f32 v[234:235], v[234:235], v[88:89]
    v_pk_add_f32 v[236:237], v[236:237], v[104:105]
    v_pk_add_f32 v[238:239], v[238:239], v[120:121]
    v_pk_add_f32 v[232:233], v[232:233], v[74:75]
    v_pk_add_f32 v[234:235], v[234:235], v[90:91]
    v_pk_add_f32 v[236:237], v[236:237], v[106:107]
    v_pk_add_f32 v[238:239], v[238:239], v[122:123]
    v_pk_add_f32 v[232:233], v[232:233], v[76:77]
    v_pk_add_f32 v[234:235], v[234:235], v[92:93]
    v_pk_add_f32 v[236:237], v[236:237], v[108:109]
    v_pk_add_f32 v[238:239], v[238:239], v[124:125]
    v_pk_add_f32 v[232:233], v[232:233], v[78:79]
    v_pk_add_f32 v[234:235], v[234:235], v[94:95]
    v_pk_add_f32 v[236:237], v[236:237], v[110:111]
    v_pk_add_f32 v[238:239], v[238:239], v[126:127]
    v_pk_add_f32 v[232:233], v[232:233], v[234:235]
    v_pk_add_f32 v[236:237], v[236:237], v[238:239]
    v_pk_add_f32 v[232:233], v[232:233], v[236:237]
    v_add_f32 v63, v232, v233
    v_mov_b32 v232, v63
    s_nop 1
    v_permlane32_swap_b32 v63, v232
    v_add_f32 v63, v63, v232
    v_mov_b32 v232, v63
    s_nop 1
    v_permlane16_swap_b32 v63, v232
    v_add_f32 v63, v63, v232
    s_waitcnt vmcnt(16)
    ds_read_b64_tr_b16 a[0:1], v12 offset:24576
    ds_read_b64_tr_b16 a[2:3], v12 offset:28672
    ds_read_b64_tr_b16 a[4:5], v13 offset:24576
    ds_read_b64_tr_b16 a[6:7], v13 offset:28672
    ds_read_b64_tr_b16 a[8:9], v14 offset:24576
    ds_read_b64_tr_b16 a[10:11], v14 offset:28672
    ds_read_b64_tr_b16 a[12:13], v15 offset:24576
    ds_read_b64_tr_b16 a[14:15], v15 offset:28672
    ds_read_b64_tr_b16 a[16:17], v16 offset:24576
    ds_read_b64_tr_b16 a[18:19], v16 offset:28672
    ds_read_b64_tr_b16 a[20:21], v17 offset:24576
    ds_read_b64_tr_b16 a[22:23], v17 offset:28672
    ds_read_b64_tr_b16 a[24:25], v18 offset:24576
    ds_read_b64_tr_b16 a[26:27], v18 offset:28672
    ds_read_b64_tr_b16 a[28:29], v19 offset:24576
    ds_read_b64_tr_b16 a[30:31], v19 offset:28672
    s_waitcnt lgkmcnt(0)
    v_mfma_f32_16x16x32_bf16 v[160:163], a[0:3], v[128:131], 0
    v_mfma_f32_16x16x32_bf16 v[164:167], a[4:7], v[128:131], 0
    v_mfma_f32_16x16x32_bf16 v[168:171], a[8:11], v[128:131], 0
    v_mfma_f32_16x16x32_bf16 v[172:175], a[12:15], v[128:131], 0
    v_mfma_f32_16x16x32_bf16 v[176:179], a[16:19], v[128:131], 0
    v_mfma_f32_16x16x32_bf16 v[180:183], a[20:23], v[128:131], 0
    v_mfma_f32_16x16x32_bf16 v[184:187], a[24:27], v[128:131], 0
    v_mfma_f32_16x16x32_bf16 v[188:191], a[28:31], v[128:131], 0
    s_waitcnt vmcnt(8)
    ds_read_b64_tr_b16 a[32:33], v12 offset:0
    ds_read_b64_tr_b16 a[34:35], v12 offset:4096
    ds_read_b64_tr_b16 a[36:37], v13 offset:0
    ds_read_b64_tr_b16 a[38:39], v13 offset:4096
    ds_read_b64_tr_b16 a[40:41], v14 offset:0
    ds_read_b64_tr_b16 a[42:43], v14 offset:4096
    ds_read_b64_tr_b16 a[44:45], v15 offset:0
    ds_read_b64_tr_b16 a[46:47], v15 offset:4096
    ds_read_b64_tr_b16 a[48:49], v16 offset:0
    ds_read_b64_tr_b16 a[50:51], v16 offset:4096
    ds_read_b64_tr_b16 a[52:53], v17 offset:0
    ds_read_b64_tr_b16 a[54:55], v17 offset:4096
    ds_read_b64_tr_b16 a[56:57], v18 offset:0
    ds_read_b64_tr_b16 a[58:59], v18 offset:4096
    ds_read_b64_tr_b16 a[60:61], v19 offset:0
    ds_read_b64_tr_b16 a[62:63], v19 offset:4096
    s_waitcnt lgkmcnt(0)
    s_add_u32 m0, s49, 16384
    s_add_u32 s51, s50, 98304
    buffer_load_dwordx4 v6, s[12:15], s51 offen nt lds
    buffer_load_dwordx4 v7, s[12:15], s51 offen offset:1024 nt lds
    buffer_load_dwordx4 v6, s[12:15], s51 offen offset:2048 nt lds
    buffer_load_dwordx4 v7, s[12:15], s51 offen offset:3072 nt lds
    v_mfma_f32_16x16x32_bf16 v[160:163], a[32:35], v[132:135], v[160:163]
    v_mfma_f32_16x16x32_bf16 v[164:167], a[36:39], v[132:135], v[164:167]
    v_mfma_f32_16x16x32_bf16 v[168:171], a[40:43], v[132:135], v[168:171]
    v_mfma_f32_16x16x32_bf16 v[172:175], a[44:47], v[132:135], v[172:175]
    v_mfma_f32_16x16x32_bf16 v[176:179], a[48:51], v[132:135], v[176:179]
    v_mfma_f32_16x16x32_bf16 v[180:183], a[52:55], v[132:135], v[180:183]
    v_mfma_f32_16x16x32_bf16 v[184:187], a[56:59], v[132:135], v[184:187]
    v_mfma_f32_16x16x32_bf16 v[188:191], a[60:63], v[132:135], v[188:191]
    s_waitcnt vmcnt(4)
    ds_read_b64_tr_b16 a[0:1], v12 offset:8192
    ds_read_b64_tr_b16 a[2:3], v12 offset:12288
    ds_read_b64_tr_b16 a[4:5], v13 offset:8192
    ds_read_b64_tr_b16 a[6:7], v13 offset:12288
    ds_read_b64_tr_b16 a[8:9], v14 offset:8192
    ds_read_b64_tr_b16 a[10:11], v14 offset:12288
    ds_read_b64_tr_b16 a[12:13], v15 offset:8192
    ds_read_b64_tr_b16 a[14:15], v15 offset:12288
    ds_read_b64_tr_b16 a[16:17], v16 offset:8192
    ds_read_b64_tr_b16 a[18:19], v16 offset:12288
    ds_read_b64_tr_b16 a[20:21], v17 offset:8192
    ds_read_b64_tr_b16 a[22:23], v17 offset:12288
    ds_read_b64_tr_b16 a[24:25], v18 offset:8192
    ds_read_b64_tr_b16 a[26:27], v18 offset:12288
    ds_read_b64_tr_b16 a[28:29], v19 offset:8192
    ds_read_b64_tr_b16 a[30:31], v19 offset:12288
    s_waitcnt lgkmcnt(0)
    s_add_u32 m0, s49, 20480
    s_add_u32 s51, s50, 102400
    buffer_load_dwordx4 v6, s[12:15], s51 offen nt lds
    buffer_load_dwordx4 v7, s[12:15], s51 offen offset:1024 nt lds
    buffer_load_dwordx4 v6, s[12:15], s51 offen offset:2048 nt lds
    buffer_load_dwordx4 v7, s[12:15], s51 offen offset:3072 nt lds
    s_add_u32 m0, s49, 24576
    s_add_u32 s51, s50, 131072
    buffer_load_dwordx4 v6, s[12:15], s51 offen nt lds
    buffer_load_dwordx4 v7, s[12:15], s51 offen offset:1024 nt lds
    buffer_load_dwordx4 v6, s[12:15], s51 offen offset:2048 nt lds
    buffer_load_dwordx4 v7, s[12:15], s51 offen offset:3072 nt lds
    v_mfma_f32_16x16x32_bf16 v[160:163], a[0:3], v[136:139], v[160:163]
    v_mfma_f32_16x16x32_bf16 v[164:167], a[4:7], v[136:139], v[164:167]
    v_mfma_f32_16x16x32_bf16 v[168:171], a[8:11], v[136:139], v[168:171]
    v_mfma_f32_16x16x32_bf16 v[172:175], a[12:15], v[136:139], v[172:175]
    v_mfma_f32_16x16x32_bf16 v[176:179], a[16:19], v[136:139], v[176:179]
    v_mfma_f32_16x16x32_bf16 v[180:183], a[20:23], v[136:139], v[180:183]
    v_mfma_f32_16x16x32_bf16 v[184:187], a[24:27], v[136:139], v[184:187]
    v_mfma_f32_16x16x32_bf16 v[188:191], a[28:31], v[136:139], v[188:191]
    v_add_u32 v233, 145664, v60
    ds_read_b128 v[192:195], v233 offset:0
    ds_read_b128 v[196:199], v233 offset:64
    ds_read_b128 v[200:203], v233 offset:128
    ds_read_b128 v[204:207], v233 offset:192
    s_waitcnt lgkmcnt(0)
    v_add_f32_dpp v192, v192, v192 row_ror:2 row_mask:0xf bank_mask:0xf
    s_nop 1
    v_add_f32_dpp v192, v192, v192 row_ror:4 row_mask:0xf bank_mask:0xf
    s_nop 1
    v_add_f32_dpp v192, v192, v192 row_ror:8 row_mask:0xf bank_mask:0xf
    v_add_f32_dpp v193, v193, v193 row_ror:2 row_mask:0xf bank_mask:0xf
    s_nop 1
    v_add_f32_dpp v193, v193, v193 row_ror:4 row_mask:0xf bank_mask:0xf
    s_nop 1
    v_add_f32_dpp v193, v193, v193 row_ror:8 row_mask:0xf bank_mask:0xf
    v_add_f32_dpp v194, v194, v194 row_ror:2 row_mask:0xf bank_mask:0xf
    s_nop 1
    v_add_f32_dpp v194, v194, v194 row_ror:4 row_mask:0xf bank_mask:0xf
    s_nop 1
    v_add_f32_dpp v194, v194, v194 row_ror:8 row_mask:0xf bank_mask:0xf
    v_add_f32_dpp v195, v195, v195 row_ror:2 row_mask:0xf bank_mask:0xf
    s_nop 1
    v_add_f32_dpp v195, v195, v195 row_ror:4 row_mask:0xf bank_mask:0xf
    s_nop 1
    v_add_f32_dpp v195, v195, v195 row_ror:8 row_mask:0xf bank_mask:0xf
    v_add_f32_dpp v196, v196, v196 row_ror:2 row_mask:0xf bank_mask:0xf
    s_nop 1
    v_add_f32_dpp v196, v196, v196 row_ror:4 row_mask:0xf bank_mask:0xf
    s_nop 1
    v_add_f32_dpp v196, v196, v196 row_ror:8 row_mask:0xf bank_mask:0xf
    v_add_f32_dpp v197, v197, v197 row_ror:2 row_mask:0xf bank_mask:0xf
    s_nop 1
    v_add_f32_dpp v197, v197, v197 row_ror:4 row_mask:0xf bank_mask:0xf
    s_nop 1
    v_add_f32_dpp v197, v197, v197 row_ror:8 row_mask:0xf bank_mask:0xf
    v_add_f32_dpp v198, v198, v198 row_ror:2 row_mask:0xf bank_mask:0xf
    s_nop 1
    v_add_f32_dpp v198, v198, v198 row_ror:4 row_mask:0xf bank_mask:0xf
    s_nop 1
    v_add_f32_dpp v198, v198, v198 row_ror:8 row_mask:0xf bank_mask:0xf
    v_add_f32_dpp v199, v199, v199 row_ror:2 row_mask:0xf bank_mask:0xf
    s_nop 1
    v_add_f32_dpp v199, v199, v199 row_ror:4 row_mask:0xf bank_mask:0xf
    s_nop 1
    v_add_f32_dpp v199, v199, v199 row_ror:8 row_mask:0xf bank_mask:0xf
    v_add_f32_dpp v200, v200, v200 row_ror:2 row_mask:0xf bank_mask:0xf
    s_nop 1
    v_add_f32_dpp v200, v200, v200 row_ror:4 row_mask:0xf bank_mask:0xf
    s_nop 1
    v_add_f32_dpp v200, v200, v200 row_ror:8 row_mask:0xf bank_mask:0xf
    v_add_f32_dpp v201, v201, v201 row_ror:2 row_mask:0xf bank_mask:0xf
    s_nop 1
    v_add_f32_dpp v201, v201, v201 row_ror:4 row_mask:0xf bank_mask:0xf
    s_nop 1
    v_add_f32_dpp v201, v201, v201 row_ror:8 row_mask:0xf bank_mask:0xf
    v_add_f32_dpp v202, v202, v202 row_ror:2 row_mask:0xf bank_mask:0xf
    s_nop 1
    v_add_f32_dpp v202, v202, v202 row_ror:4 row_mask:0xf bank_mask:0xf
    s_nop 1
    v_add_f32_dpp v202, v202, v202 row_ror:8 row_mask:0xf bank_mask:0xf
    v_add_f32_dpp v203, v203, v203 row_ror:2 row_mask:0xf bank_mask:0xf
    s_nop 1
    v_add_f32_dpp v203, v203, v203 row_ror:4 row_mask:0xf bank_mask:0xf
    s_nop 1
    v_add_f32_dpp v203, v203, v203 row_ror:8 row_mask:0xf bank_mask:0xf
    v_add_f32_dpp v204, v204, v204 row_ror:2 row_mask:0xf bank_mask:0xf
    s_nop 1
    v_add_f32_dpp v204, v204, v204 row_ror:4 row_mask:0xf bank_mask:0xf
    s_nop 1
    v_add_f32_dpp v204, v204, v204 row_ror:8 row_mask:0xf bank_mask:0xf
    v_add_f32_dpp v205, v205, v205 row_ror:2 row_mask:0xf bank_mask:0xf
    s_nop 1
    v_add_f32_dpp v205, v205, v205 row_ror:4 row_mask:0xf bank_mask:0xf
    s_nop 1
    v_add_f32_dpp v205, v205, v205 row_ror:8 row_mask:0xf bank_mask:0xf
    v_add_f32_dpp v206, v206, v206 row_ror:2 row_mask:0xf bank_mask:0xf
    s_nop 1
    v_add_f32_dpp v206, v206, v206 row_ror:4 row_mask:0xf bank_mask:0xf
    s_nop 1
    v_add_f32_dpp v206, v206, v206 row_ror:8 row_mask:0xf bank_mask:0xf
    v_add_f32_dpp v207, v207, v207 row_ror:2 row_mask:0xf bank_mask:0xf
    s_nop 1
    v_add_f32_dpp v207, v207, v207 row_ror:4 row_mask:0xf bank_mask:0xf
    s_nop 1
    v_add_f32_dpp v207, v207, v207 row_ror:8 row_mask:0xf bank_mask:0xf
    v_cvt_pk_bf16_f32 v232, v192, v193
    v_and_b32 v193, s68, v232
    v_lshlrev_b32 v192, 16, v232
    v_cvt_pk_bf16_f32 v233, v194, v195
    v_and_b32 v195, s68, v233
    v_lshlrev_b32 v194, 16, v233
    v_cvt_pk_bf16_f32 v234, v196, v197
    v_and_b32 v197, s68, v234
    v_lshlrev_b32 v196, 16, v234
    v_cvt_pk_bf16_f32 v235, v198, v199
    v_and_b32 v199, s68, v235
    v_lshlrev_b32 v198, 16, v235
    v_cvt_pk_bf16_f32 v236, v200, v201
    v_and_b32 v201, s68, v236
    v_lshlrev_b32 v200, 16, v236
    v_cvt_pk_bf16_f32 v237, v202, v203
    v_and_b32 v203, s68, v237
    v_lshlrev_b32 v202, 16, v237
    v_cvt_pk_bf16_f32 v238, v204, v205
    v_and_b32 v205, s68, v238
    v_lshlrev_b32 v204, 16, v238
    v_cvt_pk_bf16_f32 v239, v206, v207
    v_and_b32 v207, s68, v239
    v_lshlrev_b32 v206, 16, v239
    s_mov_b32 s90, 0xbfb8aa3b
    v_mul_f32 v232, s90, v192
    v_mul_f32 v233, s90, v193
    v_mul_f32 v234, s90, v194
    v_mul_f32 v235, s90, v195
    v_mul_f32 v236, s90, v196
    v_mul_f32 v237, s90, v197
    v_mul_f32 v238, s90, v198
    v_mul_f32 v239, s90, v199
    v_exp_f32 v232, v232
    v_exp_f32 v233, v233
    v_exp_f32 v234, v234
    v_exp_f32 v235, v235
    v_exp_f32 v236, v236
    v_exp_f32 v237, v237
    v_exp_f32 v238, v238
    v_exp_f32 v239, v239
    v_add_f32 v232, 1.0, v232
    v_add_f32 v233, 1.0, v233
    v_add_f32 v234, 1.0, v234
    v_add_f32 v235, 1.0, v235
    v_add_f32 v236, 1.0, v236
    v_add_f32 v237, 1.0, v237
    v_add_f32 v238, 1.0, v238
    v_add_f32 v239, 1.0, v239
    v_rcp_f32 v232, v232
    v_rcp_f32 v233, v233
    v_rcp_f32 v234, v234
    v_rcp_f32 v235, v235
    v_rcp_f32 v236, v236
    v_rcp_f32 v237, v237
    v_rcp_f32 v238, v238
    v_rcp_f32 v239, v239
    v_mul_f32 v192, v192, v232
    v_mul_f32 v193, v193, v233
    v_mul_f32 v194, v194, v234
    v_mul_f32 v195, v195, v235
    v_mul_f32 v196, v196, v236
    v_mul_f32 v197, v197, v237
    v_mul_f32 v198, v198, v238
    v_mul_f32 v199, v199, v239
    v_cvt_pk_bf16_f32 v232, v192, v193
    v_and_b32 v193, s68, v232
    v_lshlrev_b32 v192, 16, v232
    v_cvt_pk_bf16_f32 v233, v194, v195
    v_and_b32 v195, s68, v233
    v_lshlrev_b32 v194, 16, v233
    v_cvt_pk_bf16_f32 v234, v196, v197
    v_and_b32 v197, s68, v234
    v_lshlrev_b32 v196, 16, v234
    v_cvt_pk_bf16_f32 v235, v198, v199
    v_and_b32 v199, s68, v235
    v_lshlrev_b32 v198, 16, v235
    v_mul_f32 v192, v192, v200
    v_mul_f32 v193, v193, v201
    v_mul_f32 v194, v194, v202
    v_mul_f32 v195, v195, v203
    v_mul_f32 v196, v196, v204
    v_mul_f32 v197, v197, v205
    v_mul_f32 v198, v198, v206
    v_mul_f32 v199, v199, v207
    v_cvt_pk_bf16_f32 v30, v192, v193
    v_cvt_pk_bf16_f32 v31, v194, v195
    v_cvt_pk_bf16_f32 v32, v196, v197
    v_cvt_pk_bf16_f32 v33, v198, v199
    s_waitcnt vmcnt(4)
    ds_read_b64_tr_b16 a[32:33], v12 offset:16384
    ds_read_b64_tr_b16 a[34:35], v12 offset:20480
    ds_read_b64_tr_b16 a[36:37], v13 offset:16384
    ds_read_b64_tr_b16 a[38:39], v13 offset:20480
    ds_read_b64_tr_b16 a[40:41], v14 offset:16384
    ds_read_b64_tr_b16 a[42:43], v14 offset:20480
    ds_read_b64_tr_b16 a[44:45], v15 offset:16384
    ds_read_b64_tr_b16 a[46:47], v15 offset:20480
    ds_read_b64_tr_b16 a[48:49], v16 offset:16384
    ds_read_b64_tr_b16 a[50:51], v16 offset:20480
    ds_read_b64_tr_b16 a[52:53], v17 offset:16384
    ds_read_b64_tr_b16 a[54:55], v17 offset:20480
    ds_read_b64_tr_b16 a[56:57], v18 offset:16384
    ds_read_b64_tr_b16 a[58:59], v18 offset:20480
    ds_read_b64_tr_b16 a[60:61], v19 offset:16384
    ds_read_b64_tr_b16 a[62:63], v19 offset:20480
    s_waitcnt lgkmcnt(0)
    s_add_u32 m0, s49, 28672
    s_add_u32 s51, s50, 135168
    buffer_load_dwordx4 v6, s[12:15], s51 offen nt lds
    buffer_load_dwordx4 v7, s[12:15], s51 offen offset:1024 nt lds
    buffer_load_dwordx4 v6, s[12:15], s51 offen offset:2048 nt lds
    buffer_load_dwordx4 v7, s[12:15], s51 offen offset:3072 nt lds
    s_add_u32 m0, s49, 0
    s_add_u32 s51, s50, 163840
    buffer_load_dwordx4 v6, s[12:15], s51 offen nt lds
    buffer_load_dwordx4 v7, s[12:15], s51 offen offset:1024 nt lds
    buffer_load_dwordx4 v6, s[12:15], s51 offen offset:2048 nt lds
    buffer_load_dwordx4 v7, s[12:15], s51 offen offset:3072 nt lds
    v_mfma_f32_16x16x32_bf16 v[160:163], a[32:35], v[140:143], v[160:163]
    v_mfma_f32_16x16x32_bf16 v[164:167], a[36:39], v[140:143], v[164:167]
    v_mfma_f32_16x16x32_bf16 v[168:171], a[40:43], v[140:143], v[168:171]
    v_mfma_f32_16x16x32_bf16 v[172:175], a[44:47], v[140:143], v[172:175]
    v_mfma_f32_16x16x32_bf16 v[176:179], a[48:51], v[140:143], v[176:179]
    v_mfma_f32_16x16x32_bf16 v[180:183], a[52:55], v[140:143], v[180:183]
    v_mfma_f32_16x16x32_bf16 v[184:187], a[56:59], v[140:143], v[184:187]
    v_mfma_f32_16x16x32_bf16 v[188:191], a[60:63], v[140:143], v[188:191]
    s_waitcnt vmcnt(4)
    ds_read_b64_tr_b16 a[0:1], v12 offset:24576
    ds_read_b64_tr_b16 a[2:3], v12 offset:28672
    ds_read_b64_tr_b16 a[4:5], v13 offset:24576
    ds_read_b64_tr_b16 a[6:7], v13 offset:28672
    ds_read_b64_tr_b16 a[8:9], v14 offset:24576
    ds_read_b64_tr_b16 a[10:11], v14 offset:28672
    ds_read_b64_tr_b16 a[12:13], v15 offset:24576
    ds_read_b64_tr_b16 a[14:15], v15 offset:28672
    ds_read_b64_tr_b16 a[16:17], v16 offset:24576
    ds_read_b64_tr_b16 a[18:19], v16 offset:28672
    ds_read_b64_tr_b16 a[20:21], v17 offset:24576
    ds_read_b64_tr_b16 a[22:23], v17 offset:28672
    ds_read_b64_tr_b16 a[24:25], v18 offset:24576
    ds_read_b64_tr_b16 a[26:27], v18 offset:28672
    ds_read_b64_tr_b16 a[28:29], v19 offset:24576
    ds_read_b64_tr_b16 a[30:31], v19 offset:28672
    s_waitcnt lgkmcnt(0)
    s_add_u32 m0, s49, 4096
    s_add_u32 s51, s50, 167936
    buffer_load_dwordx4 v6, s[12:15], s51 offen nt lds
    buffer_load_dwordx4 v7, s[12:15], s51 offen offset:1024 nt lds
    buffer_load_dwordx4 v6, s[12:15], s51 offen offset:2048 nt lds
    buffer_load_dwordx4 v7, s[12:15], s51 offen offset:3072 nt lds
    s_add_u32 m0, s49, 8192
    s_add_u32 s51, s50, 196608
    buffer_load_dwordx4 v6, s[12:15], s51 offen nt lds
    buffer_load_dwordx4 v7, s[12:15], s51 offen offset:1024 nt lds
    buffer_load_dwordx4 v6, s[12:15], s51 offen offset:2048 nt lds
    buffer_load_dwordx4 v7, s[12:15], s51 offen offset:3072 nt lds
    v_mfma_f32_16x16x32_bf16 v[160:163], a[0:3], v[144:147], v[160:163]
    v_mfma_f32_16x16x32_bf16 v[164:167], a[4:7], v[144:147], v[164:167]
    v_mfma_f32_16x16x32_bf16 v[168:171], a[8:11], v[144:147], v[168:171]
    v_mfma_f32_16x16x32_bf16 v[172:175], a[12:15], v[144:147], v[172:175]
    v_mfma_f32_16x16x32_bf16 v[176:179], a[16:19], v[144:147], v[176:179]
    v_mfma_f32_16x16x32_bf16 v[180:183], a[20:23], v[144:147], v[180:183]
    v_mfma_f32_16x16x32_bf16 v[184:187], a[24:27], v[144:147], v[184:187]
    v_mfma_f32_16x16x32_bf16 v[188:191], a[28:31], v[144:147], v[188:191]
    s_waitcnt vmcnt(4)
    ds_read_b64_tr_b16 a[32:33], v12 offset:0
    ds_read_b64_tr_b16 a[34:35], v12 offset:4096
    ds_read_b64_tr_b16 a[36:37], v13 offset:0
    ds_read_b64_tr_b16 a[38:39], v13 offset:4096
    ds_read_b64_tr_b16 a[40:41], v14 offset:0
    ds_read_b64_tr_b16 a[42:43], v14 offset:4096
    ds_read_b64_tr_b16 a[44:45], v15 offset:0
    ds_read_b64_tr_b16 a[46:47], v15 offset:4096
    ds_read_b64_tr_b16 a[48:49], v16 offset:0
    ds_read_b64_tr_b16 a[50:51], v16 offset:4096
    ds_read_b64_tr_b16 a[52:53], v17 offset:0
    ds_read_b64_tr_b16 a[54:55], v17 offset:4096
    ds_read_b64_tr_b16 a[56:57], v18 offset:0
    ds_read_b64_tr_b16 a[58:59], v18 offset:4096
    ds_read_b64_tr_b16 a[60:61], v19 offset:0
    ds_read_b64_tr_b16 a[62:63], v19 offset:4096
    s_waitcnt lgkmcnt(0)
    s_add_u32 m0, s49, 12288
    s_add_u32 s51, s50, 200704
    buffer_load_dwordx4 v6, s[12:15], s51 offen nt lds
    buffer_load_dwordx4 v7, s[12:15], s51 offen offset:1024 nt lds
    buffer_load_dwordx4 v6, s[12:15], s51 offen offset:2048 nt lds
    buffer_load_dwordx4 v7, s[12:15], s51 offen offset:3072 nt lds
    s_add_u32 m0, s49, 16384
    s_add_u32 s51, s50, 229376
    buffer_load_dwordx4 v6, s[12:15], s51 offen nt lds
    buffer_load_dwordx4 v7, s[12:15], s51 offen offset:1024 nt lds
    buffer_load_dwordx4 v6, s[12:15], s51 offen offset:2048 nt lds
    buffer_load_dwordx4 v7, s[12:15], s51 offen offset:3072 nt lds
    v_mfma_f32_16x16x32_bf16 v[160:163], a[32:35], v[148:151], v[160:163]
    v_mfma_f32_16x16x32_bf16 v[164:167], a[36:39], v[148:151], v[164:167]
    v_mfma_f32_16x16x32_bf16 v[168:171], a[40:43], v[148:151], v[168:171]
    v_mfma_f32_16x16x32_bf16 v[172:175], a[44:47], v[148:151], v[172:175]
    v_mfma_f32_16x16x32_bf16 v[176:179], a[48:51], v[148:151], v[176:179]
    v_mfma_f32_16x16x32_bf16 v[180:183], a[52:55], v[148:151], v[180:183]
    v_mfma_f32_16x16x32_bf16 v[184:187], a[56:59], v[148:151], v[184:187]
    v_mfma_f32_16x16x32_bf16 v[188:191], a[60:63], v[148:151], v[188:191]
    s_waitcnt vmcnt(4)
    ds_read_b64_tr_b16 a[0:1], v12 offset:8192
    ds_read_b64_tr_b16 a[2:3], v12 offset:12288
    ds_read_b64_tr_b16 a[4:5], v13 offset:8192
    ds_read_b64_tr_b16 a[6:7], v13 offset:12288
    ds_read_b64_tr_b16 a[8:9], v14 offset:8192
    ds_read_b64_tr_b16 a[10:11], v14 offset:12288
    ds_read_b64_tr_b16 a[12:13], v15 offset:8192
    ds_read_b64_tr_b16 a[14:15], v15 offset:12288
    ds_read_b64_tr_b16 a[16:17], v16 offset:8192
    ds_read_b64_tr_b16 a[18:19], v16 offset:12288
    ds_read_b64_tr_b16 a[20:21], v17 offset:8192
    ds_read_b64_tr_b16 a[22:23], v17 offset:12288
    ds_read_b64_tr_b16 a[24:25], v18 offset:8192
    ds_read_b64_tr_b16 a[26:27], v18 offset:12288
    ds_read_b64_tr_b16 a[28:29], v19 offset:8192
    ds_read_b64_tr_b16 a[30:31], v19 offset:12288
    s_waitcnt lgkmcnt(0)
    s_add_u32 m0, s49, 20480
    s_add_u32 s51, s50, 233472
    buffer_load_dwordx4 v6, s[12:15], s51 offen nt lds
    buffer_load_dwordx4 v7, s[12:15], s51 offen offset:1024 nt lds
    buffer_load_dwordx4 v6, s[12:15], s51 offen offset:2048 nt lds
    buffer_load_dwordx4 v7, s[12:15], s51 offen offset:3072 nt lds
    v_mfma_f32_16x16x32_bf16 v[160:163], a[0:3], v[152:155], v[160:163]
    v_mfma_f32_16x16x32_bf16 v[164:167], a[4:7], v[152:155], v[164:167]
    v_mfma_f32_16x16x32_bf16 v[168:171], a[8:11], v[152:155], v[168:171]
    v_mfma_f32_16x16x32_bf16 v[172:175], a[12:15], v[152:155], v[172:175]
    v_mfma_f32_16x16x32_bf16 v[176:179], a[16:19], v[152:155], v[176:179]
    v_mfma_f32_16x16x32_bf16 v[180:183], a[20:23], v[152:155], v[180:183]
    v_mfma_f32_16x16x32_bf16 v[184:187], a[24:27], v[152:155], v[184:187]
    v_mfma_f32_16x16x32_bf16 v[188:191], a[28:31], v[152:155], v[188:191]
    s_waitcnt vmcnt(0)
    ds_read_b64_tr_b16 a[32:33], v12 offset:16384
    ds_read_b64_tr_b16 a[34:35], v12 offset:20480
    ds_read_b64_tr_b16 a[36:37], v13 offset:16384
    ds_read_b64_tr_b16 a[38:39], v13 offset:20480
    ds_read_b64_tr_b16 a[40:41], v14 offset:16384
    ds_read_b64_tr_b16 a[42:43], v14 offset:20480
    ds_read_b64_tr_b16 a[44:45], v15 offset:16384
    ds_read_b64_tr_b16 a[46:47], v15 offset:20480
    ds_read_b64_tr_b16 a[48:49], v16 offset:16384
    ds_read_b64_tr_b16 a[50:51], v16 offset:20480
    ds_read_b64_tr_b16 a[52:53], v17 offset:16384
    ds_read_b64_tr_b16 a[54:55], v17 offset:20480
    ds_read_b64_tr_b16 a[56:57], v18 offset:16384
    ds_read_b64_tr_b16 a[58:59], v18 offset:20480
    ds_read_b64_tr_b16 a[60:61], v19 offset:16384
    ds_read_b64_tr_b16 a[62:63], v19 offset:20480
    s_waitcnt lgkmcnt(0)
    s_add_u32 m0, s49, 24576
    s_add_u32 s51, s88, 0
    buffer_load_dwordx4 v24, s[32:35], s51 offen nt lds
    buffer_load_dwordx4 v25, s[32:35], s51 offen offset:1024 nt lds
    s_add_u32 m0, s49, 26624
    s_add_u32 s51, s88, 16384
    buffer_load_dwordx4 v24, s[32:35], s51 offen nt lds
    buffer_load_dwordx4 v25, s[32:35], s51 offen offset:1024 nt lds
    s_add_u32 m0, s49, 28672
    s_add_u32 s51, s88, 32768
    buffer_load_dwordx4 v24, s[32:35], s51 offen nt lds
    buffer_load_dwordx4 v25, s[32:35], s51 offen offset:1024 nt lds
    s_add_u32 m0, s49, 30720
    s_add_u32 s51, s88, 49152
    buffer_load_dwordx4 v24, s[32:35], s51 offen nt lds
    buffer_load_dwordx4 v25, s[32:35], s51 offen offset:1024 nt lds
    v_mfma_f32_16x16x32_bf16 v[160:163], a[32:35], v[156:159], v[160:163]
    v_mfma_f32_16x16x32_bf16 v[164:167], a[36:39], v[156:159], v[164:167]
    v_mfma_f32_16x16x32_bf16 v[168:171], a[40:43], v[156:159], v[168:171]
    v_mfma_f32_16x16x32_bf16 v[172:175], a[44:47], v[156:159], v[172:175]
    v_mfma_f32_16x16x32_bf16 v[176:179], a[48:51], v[156:159], v[176:179]
    v_mfma_f32_16x16x32_bf16 v[180:183], a[52:55], v[156:159], v[180:183]
    v_mfma_f32_16x16x32_bf16 v[184:187], a[56:59], v[156:159], v[184:187]
    v_mfma_f32_16x16x32_bf16 v[188:191], a[60:63], v[156:159], v[188:191]
    v_and_b32 v232, 7, v224
    v_mul_u32_u24 v232, 528, v232
    v_lshl_add_u32 v232, v225, 4, v232
    v_add_u32 v232, s49, v232
    s_lshl_b32 s90, s3, 6
    s_add_u32 s90, s90, 150016
    v_lshlrev_b32 v233, 3, v224
    v_add_u32 v233, s90, v233
    s_mov_b64 s[70:71], exec
    s_mov_b32 exec_lo, 0x00ff00ff
    s_mov_b32 exec_hi, 0x00ff00ff
    ds_write_b128 v232, v[160:163] offset:16384
    ds_write_b128 v232, v[164:167] offset:16448
    ds_write_b128 v232, v[168:171] offset:16512
    ds_write_b128 v232, v[172:175] offset:16576
    ds_write_b128 v232, v[176:179] offset:16640
    ds_write_b128 v232, v[180:183] offset:16704
    ds_write_b128 v232, v[184:187] offset:16768
    ds_write_b128 v232, v[188:191] offset:16832
    s_mov_b32 exec_lo, 0x000000ff
    s_mov_b32 exec_hi, 0
    ds_write_b64 v233, v[62:63]
    s_mov_b64 exec, s[70:71]
    v_lshrrev_b32 v234, 5, v1
    s_lshl_b32 s90, s3, 1
    v_add_u32 v234, s90, v234
    v_and_b32 v237, 31, v1
    v_lshlrev_b32 v237, 4, v237
    v_mul_u32_u24 v236, 528, v234
    v_add_u32 v235, v237, v236
    v_lshlrev_b32 v236, 3, v234
    v_add_u32 v236, 150016, v236
    v_lshl_add_u32 v237, v234, 9, v237
    v_lshlrev_b32 v238, 9, v234
    v_mov_b32 v239, 2146435072
    v_and_b32 v240, 31, v1
    v_cmp_eq_u32 vcc, 0, v240
    s_nop 1
    v_cndmask_b32 v238, v239, v238, vcc
    v_add_u32 v239, 0x8000, v235
    v_add_u32 v240, 0x10000, v235
    v_add_u32 v241, 0x18000, v235
    s_waitcnt lgkmcnt(0)
    s_barrier
    ds_read_b64 v[80:81], v236 offset:0
    ds_read_b64 v[82:83], v236 offset:64
    ds_read_b64 v[84:85], v236 offset:128
    ds_read_b64 v[86:87], v236 offset:192
    ds_read_b128 v[64:67], v235 offset:16384
    ds_read_b128 v[68:71], v239 offset:16384
    ds_read_b128 v[72:75], v240 offset:16384
    ds_read_b128 v[76:79], v241 offset:16384
    s_waitcnt lgkmcnt(4)
    v_max3_f32 v88, v80, v82, v84
    v_max_f32 v88, v88, v86
    v_sub_f32 v80, v80, v88
    v_sub_f32 v82, v82, v88
    v_sub_f32 v84, v84, v88
    v_sub_f32 v86, v86, v88
    v_exp_f32 v80, v80
    v_exp_f32 v82, v82
    v_exp_f32 v84, v84
    v_exp_f32 v86, v86
    v_mul_f32 v90, v80, v81
    v_fma_f32 v90, v82, v83, v90
    v_fma_f32 v90, v84, v85, v90
    v_fma_f32 v90, v86, v87, v90
    v_mov_b32 v89, v38
    v_mov_b32 v91, v38
    s_waitcnt lgkmcnt(0)
    v_mul_f32 v92, v80, v64
    v_mul_f32 v93, v80, v65
    v_mul_f32 v94, v80, v66
    v_mul_f32 v95, v80, v67
    v_fma_f32 v92, v82, v68, v92
    v_fma_f32 v93, v82, v69, v93
    v_fma_f32 v94, v82, v70, v94
    v_fma_f32 v95, v82, v71, v95
    v_fma_f32 v92, v84, v72, v92
    v_fma_f32 v93, v84, v73, v93
    v_fma_f32 v94, v84, v74, v94
    v_fma_f32 v95, v84, v75, v95
    v_fma_f32 v92, v86, v76, v92
    v_fma_f32 v93, v86, v77, v93
    v_fma_f32 v94, v86, v78, v94
    v_fma_f32 v95, v86, v79, v95
    v_perm_b32 v92, v92, v38, s52
    v_perm_b32 v93, v93, v38, s53
    v_perm_b32 v94, v94, v38, s54
    v_perm_b32 v95, v95, v38, s55
    buffer_store_dwordx4 v[92:95], v237, s[36:39], s78 offen sc1
    buffer_store_dwordx4 v[88:91], v238, s[36:39], s79 offen sc1
    s_add_u32 m0, s49, 0
    s_add_u32 s51, s88, 0
    buffer_load_dwordx4 v24, s[28:31], s51 offen nt lds
    buffer_load_dwordx4 v25, s[28:31], s51 offen offset:1024 nt lds
    s_add_u32 m0, s49, 2048
    s_add_u32 s51, s88, 16384
    buffer_load_dwordx4 v24, s[28:31], s51 offen nt lds
    buffer_load_dwordx4 v25, s[28:31], s51 offen offset:1024 nt lds
    s_add_u32 m0, s49, 4096
    s_add_u32 s51, s88, 32768
    buffer_load_dwordx4 v24, s[28:31], s51 offen nt lds
    buffer_load_dwordx4 v25, s[28:31], s51 offen offset:1024 nt lds
    s_add_u32 m0, s49, 6144
    s_add_u32 s51, s88, 49152
    buffer_load_dwordx4 v24, s[28:31], s51 offen nt lds
    buffer_load_dwordx4 v25, s[28:31], s51 offen offset:1024 nt lds
    v_lshrrev_b32 v242, 1, v224
    s_lshr_b32 s90, s6, 5
    s_lshr_b32 s91, s6, 2
    s_and_b32 s91, s91, 7
    s_and_b32 s92, s6, 3
    s_lshl_b32 s93, s90, 17
    s_lshl_b32 s94, s3, 15
    s_add_u32 s93, s93, s94
    s_lshl_b32 s94, s91, 9
    s_add_u32 s93, s93, s94
    s_lshl_b32 s94, s92, 7
    s_add_u32 s93, s93, s94
    s_add_u32 s80, s93, 2097152
    v_lshlrev_b32 v243, 19, v226
    v_lshl_add_u32 v243, v242, 12, v243
    v_lshl_add_u32 v243, v225, 4, v243
    s_lshl_b32 s93, s90, 12
    s_lshl_b32 s94, s91, 9
    s_add_u32 s93, s93, s94
    s_add_u32 s95, s93, 4194304
    s_lshl_b32 s94, s3, 7
    s_add_u32 s96, s95, s94
    v_lshlrev_b32 v245, 14, v226
    v_lshl_add_u32 v245, v242, 4, v245
    v_lshl_add_u32 v244, v225, 7, v245
    s_waitcnt vmcnt(8)
    buffer_load_dwordx4 v[104:107], v243, s[36:39], s80 offen sc1
    buffer_load_dwordx4 v[108:111], v243, s[36:39], s80 offen offset:64 sc1
    buffer_load_dwordx4 v[120:123], v244, s[36:39], s95 offen sc1
    buffer_load_dwordx4 v[124:127], v245, s[36:39], s96 offen sc1
    v_lshlrev_b32 v61, 15, v242
    v_lshl_add_u32 v61, v226, 6, v61
    v_lshl_add_u32 v61, v225, 4, v61
    s_lshl_b32 s81, s7, 20
    s_lshl_b32 s82, s3, 18
    s_add_u32 s81, s81, s82
    s_lshl_b32 s82, s6, 8
    s_add_u32 s81, s81, s82
    s_add_u32 s81, s81, 4718592
    ds_read_b64_tr_b16 a[64:65], v12 offset:24576
    ds_read_b64_tr_b16 a[66:67], v12 offset:28672
    ds_read_b64_tr_b16 a[68:69], v13 offset:24576
    ds_read_b64_tr_b16 a[70:71], v13 offset:28672
    ds_read_b64_tr_b16 a[72:73], v14 offset:24576
    ds_read_b64_tr_b16 a[74:75], v14 offset:28672
    ds_read_b64_tr_b16 a[76:77], v15 offset:24576
    ds_read_b64_tr_b16 a[78:79], v15 offset:28672
    ds_read_b64_tr_b16 a[80:81], v16 offset:24576
    ds_read_b64_tr_b16 a[82:83], v16 offset:28672
    ds_read_b64_tr_b16 a[84:85], v17 offset:24576
    ds_read_b64_tr_b16 a[86:87], v17 offset:28672
    ds_read_b64_tr_b16 a[88:89], v18 offset:24576
    ds_read_b64_tr_b16 a[90:91], v18 offset:28672
    ds_read_b64_tr_b16 a[92:93], v19 offset:24576
    ds_read_b64_tr_b16 a[94:95], v19 offset:28672
    s_waitcnt lgkmcnt(0)
    v_mfma_f32_16x16x32_bf16 v[160:163], a[64:67], v[30:33], 0
    v_mfma_f32_16x16x32_bf16 v[164:167], a[68:71], v[30:33], 0
    v_mfma_f32_16x16x32_bf16 v[168:171], a[72:75], v[30:33], 0
    v_mfma_f32_16x16x32_bf16 v[172:175], a[76:79], v[30:33], 0
    v_mfma_f32_16x16x32_bf16 v[176:179], a[80:83], v[30:33], 0
    v_mfma_f32_16x16x32_bf16 v[180:183], a[84:87], v[30:33], 0
    v_mfma_f32_16x16x32_bf16 v[184:187], a[88:91], v[30:33], 0
    v_mfma_f32_16x16x32_bf16 v[188:191], a[92:95], v[30:33], 0
    s_mov_b64 s[70:71], exec
    s_mov_b32 exec_lo, 0x00030003
    s_mov_b32 exec_hi, 0x00030003
    v_mov_b32 v204, v160
    v_mov_b32 v205, v161
    v_mov_b32 v206, v162
    v_mov_b32 v207, v163
    s_lshl_b64 exec, exec, 2
    v_mov_b32 v204, v164
    v_mov_b32 v205, v165
    v_mov_b32 v206, v166
    v_mov_b32 v207, v167
    s_lshl_b64 exec, exec, 2
    v_mov_b32 v204, v168
    v_mov_b32 v205, v169
    v_mov_b32 v206, v170
    v_mov_b32 v207, v171
    s_lshl_b64 exec, exec, 2
    v_mov_b32 v204, v172
    v_mov_b32 v205, v173
    v_mov_b32 v206, v174
    v_mov_b32 v207, v175
    s_lshl_b64 exec, exec, 2
    v_mov_b32 v204, v176
    v_mov_b32 v205, v177
    v_mov_b32 v206, v178
    v_mov_b32 v207, v179
    s_lshl_b64 exec, exec, 2
    v_mov_b32 v204, v180
    v_mov_b32 v205, v181
    v_mov_b32 v206, v182
    v_mov_b32 v207, v183
    s_lshl_b64 exec, exec, 2
    v_mov_b32 v204, v184
    v_mov_b32 v205, v185
    v_mov_b32 v206, v186
    v_mov_b32 v207, v187
    s_lshl_b64 exec, exec, 2
    v_mov_b32 v204, v188
    v_mov_b32 v205, v189
    v_mov_b32 v206, v190
    v_mov_b32 v207, v191
    s_mov_b64 exec, s[70:71]
    v_perm_b32 v204, v204, v38, s52
    v_perm_b32 v205, v205, v38, s53
    v_perm_b32 v206, v206, v38, s54
    v_perm_b32 v207, v207, v38, s55
    s_waitcnt vmcnt(4)
    ds_read_b64_tr_b16 a[96:97], v12 offset:0
    ds_read_b64_tr_b16 a[98:99], v12 offset:4096
    ds_read_b64_tr_b16 a[100:101], v13 offset:0
    ds_read_b64_tr_b16 a[102:103], v13 offset:4096
    ds_read_b64_tr_b16 a[104:105], v14 offset:0
    ds_read_b64_tr_b16 a[106:107], v14 offset:4096
    ds_read_b64_tr_b16 a[108:109], v15 offset:0
    ds_read_b64_tr_b16 a[110:111], v15 offset:4096
    ds_read_b64_tr_b16 a[112:113], v16 offset:0
    ds_read_b64_tr_b16 a[114:115], v16 offset:4096
    ds_read_b64_tr_b16 a[116:117], v17 offset:0
    ds_read_b64_tr_b16 a[118:119], v17 offset:4096
    ds_read_b64_tr_b16 a[120:121], v18 offset:0
    ds_read_b64_tr_b16 a[122:123], v18 offset:4096
    ds_read_b64_tr_b16 a[124:125], v19 offset:0
    ds_read_b64_tr_b16 a[126:127], v19 offset:4096
    s_waitcnt vmcnt(0)
    v_perm_b32 v234, v105, v104, s56
    v_perm_b32 v232, v107, v106, s57
    v_or_b32 v234, v234, v232
    v_perm_b32 v235, v109, v108, s56
    v_perm_b32 v232, v111, v110, s57
    v_or_b32 v235, v235, v232
    v_min3_u32 v232, v121, v123, v125
    v_min3_u32 v232, v232, v127, v234
    v_min_u32 v232, v232, v235
    v_max3_u32 v233, v121, v123, v125
    v_max3_u32 v233, v233, v127, v234
    v_max_u32 v233, v233, v235
    v_xor_b32 v232, s48, v232
    v_xor_b32 v233, s48, v233
    v_or_b32 v232, v232, v233
    v_cmp_ne_u32 vcc, 0, v232
    s_cbranch_vccnz SLOW2
BACK2:
    v_mov_b32 v232, v120
    s_nop 1
    v_max_f32_dpp v232, v232, v232 row_ror:2 row_mask:0xf bank_mask:0xf
    s_nop 1
    v_max_f32_dpp v232, v232, v232 row_ror:4 row_mask:0xf bank_mask:0xf
    s_nop 1
    v_max_f32_dpp v232, v232, v232 row_ror:8 row_mask:0xf bank_mask:0xf
    v_mov_b32 v233, v232
    s_nop 1
    v_permlane16_swap_b32 v232, v233
    v_max_f32 v232, v232, v233
    v_mov_b32 v233, v232
    s_nop 1
    v_permlane32_swap_b32 v232, v233
    v_max_f32 v232, v232, v233
    v_sub_f32 v234, v120, v232
    v_sub_f32 v235, v124, v232
    v_exp_f32 v234, v234
    v_exp_f32 v235, v235
    v_and_b32 v104, s58, v104
    v_and_b32 v105, s58, v105
    v_and_b32 v106, s58, v106
    v_and_b32 v107, s58, v107
    v_and_b32 v108, s58, v108
    v_and_b32 v109, s58, v109
    v_and_b32 v110, s58, v110
    v_and_b32 v111, s58, v111
    v_mul_f32 v234, v234, v122
    v_mul_f32 v64, v235, v104
    v_mul_f32 v65, v235, v105
    v_mul_f32 v66, v235, v106
    v_mul_f32 v67, v235, v107
    v_mul_f32 v68, v235, v108
    v_mul_f32 v69, v235, v109
    v_mul_f32 v70, v235, v110
    v_mul_f32 v71, v235, v111
    v_add_f32_dpp v64, v64, v64 row_ror:2 row_mask:0xf bank_mask:0xf
    v_add_f32_dpp v65, v65, v65 row_ror:2 row_mask:0xf bank_mask:0xf
    v_add_f32_dpp v66, v66, v66 row_ror:2 row_mask:0xf bank_mask:0xf
    v_add_f32_dpp v67, v67, v67 row_ror:2 row_mask:0xf bank_mask:0xf
    v_add_f32_dpp v68, v68, v68 row_ror:2 row_mask:0xf bank_mask:0xf
    v_add_f32_dpp v69, v69, v69 row_ror:2 row_mask:0xf bank_mask:0xf
    v_add_f32_dpp v70, v70, v70 row_ror:2 row_mask:0xf bank_mask:0xf
    v_add_f32_dpp v71, v71, v71 row_ror:2 row_mask:0xf bank_mask:0xf
    v_add_f32_dpp v234, v234, v234 row_ror:2 row_mask:0xf bank_mask:0xf
    v_add_f32_dpp v64, v64, v64 row_ror:4 row_mask:0xf bank_mask:0xf
    v_add_f32_dpp v65, v65, v65 row_ror:4 row_mask:0xf bank_mask:0xf
    v_add_f32_dpp v66, v66, v66 row_ror:4 row_mask:0xf bank_mask:0xf
    v_add_f32_dpp v67, v67, v67 row_ror:4 row_mask:0xf bank_mask:0xf
    v_add_f32_dpp v68, v68, v68 row_ror:4 row_mask:0xf bank_mask:0xf
    v_add_f32_dpp v69, v69, v69 row_ror:4 row_mask:0xf bank_mask:0xf
    v_add_f32_dpp v70, v70, v70 row_ror:4 row_mask:0xf bank_mask:0xf
    v_add_f32_dpp v71, v71, v71 row_ror:4 row_mask:0xf bank_mask:0xf
    v_add_f32_dpp v234, v234, v234 row_ror:4 row_mask:0xf bank_mask:0xf
    v_add_f32_dpp v64, v64, v64 row_ror:8 row_mask:0xf bank_mask:0xf
    v_add_f32_dpp v65, v65, v65 row_ror:8 row_mask:0xf bank_mask:0xf
    v_add_f32_dpp v66, v66, v66 row_ror:8 row_mask:0xf bank_mask:0xf
    v_add_f32_dpp v67, v67, v67 row_ror:8 row_mask:0xf bank_mask:0xf
    v_add_f32_dpp v68, v68, v68 row_ror:8 row_mask:0xf bank_mask:0xf
    v_add_f32_dpp v69, v69, v69 row_ror:8 row_mask:0xf bank_mask:0xf
    v_add_f32_dpp v70, v70, v70 row_ror:8 row_mask:0xf bank_mask:0xf
    v_add_f32_dpp v71, v71, v71 row_ror:8 row_mask:0xf bank_mask:0xf
    v_add_f32_dpp v234, v234, v234 row_ror:8 row_mask:0xf bank_mask:0xf
    s_lshl_b32 s90, s3, 8
    s_add_u32 s90, s90, 150272
    v_lshlrev_b32 v237, 7, v226
    v_lshl_add_u32 v237, v225, 5, v237
    v_add_u32 v238, s90, v237
    v_add_u32 v237, 150272, v237
    s_mov_b64 s[70:71], exec
    s_mov_b32 exec_lo, 0x00030003
    s_mov_b32 exec_hi, 0x00030003
    ds_write_b128 v238, v[64:67]
    ds_write_b128 v238, v[68:71] offset:16
    s_mov_b64 exec, s[70:71]
    v_mov_b32 v233, v234
    s_nop 1
    v_permlane16_swap_b32 v234, v233
    v_add_f32 v234, v234, v233
    v_mov_b32 v233, v234
    s_nop 1
    v_permlane32_swap_b32 v234, v233
    v_add_f32 v234, v234, v233
    v_rcp_f32 v236, v234
    s_nop 0
    v_fma_f32 v239, -v234, v236, 1.0
    v_fma_f32 v236, v239, v236, v236
    s_waitcnt lgkmcnt(0)
    s_barrier
    ds_read_b128 v[72:75], v237 offset:0
    ds_read_b128 v[76:79], v237 offset:16
    ds_read_b128 v[80:83], v237 offset:256
    ds_read_b128 v[84:87], v237 offset:272
    ds_read_b128 v[88:91], v237 offset:512
    ds_read_b128 v[92:95], v237 offset:528
    ds_read_b128 v[96:99], v237 offset:768
    ds_read_b128 v[100:103], v237 offset:784
    s_waitcnt lgkmcnt(0)
    v_pk_add_f32 v[72:73], v[72:73], v[80:81]
    v_pk_add_f32 v[88:89], v[88:89], v[96:97]
    v_pk_add_f32 v[72:73], v[72:73], v[88:89]
    v_pk_add_f32 v[74:75], v[74:75], v[82:83]
    v_pk_add_f32 v[90:91], v[90:91], v[98:99]
    v_pk_add_f32 v[74:75], v[74:75], v[90:91]
    v_pk_add_f32 v[76:77], v[76:77], v[84:85]
    v_pk_add_f32 v[92:93], v[92:93], v[100:101]
    v_pk_add_f32 v[76:77], v[76:77], v[92:93]
    v_pk_add_f32 v[78:79], v[78:79], v[86:87]
    v_pk_add_f32 v[94:95], v[94:95], v[102:103]
    v_pk_add_f32 v[78:79], v[78:79], v[94:95]
    v_mul_f32 v72, v72, v236
    v_mul_f32 v73, v73, v236
    v_mul_f32 v74, v74, v236
    v_mul_f32 v75, v75, v236
    v_mul_f32 v76, v76, v236
    v_mul_f32 v77, v77, v236
    v_mul_f32 v78, v78, v236
    v_mul_f32 v79, v79, v236
    v_cvt_pk_bf16_f32 v34, v72, v73
    v_cvt_pk_bf16_f32 v35, v74, v75
    v_cvt_pk_bf16_f32 v36, v76, v77
    v_cvt_pk_bf16_f32 v37, v78, v79
    s_nop 1
    v_mfma_f32_16x16x32_bf16 v[160:163], a[96:99], v[34:37], 0
    v_mfma_f32_16x16x32_bf16 v[164:167], a[100:103], v[34:37], 0
    v_mfma_f32_16x16x32_bf16 v[168:171], a[104:107], v[34:37], 0
    v_mfma_f32_16x16x32_bf16 v[172:175], a[108:111], v[34:37], 0
    v_mfma_f32_16x16x32_bf16 v[176:179], a[112:115], v[34:37], 0
    v_mfma_f32_16x16x32_bf16 v[180:183], a[116:119], v[34:37], 0
    v_mfma_f32_16x16x32_bf16 v[184:187], a[120:123], v[34:37], 0
    v_mfma_f32_16x16x32_bf16 v[188:191], a[124:127], v[34:37], 0
    s_mov_b64 s[70:71], exec
    s_mov_b32 exec_lo, 0x00030003
    s_mov_b32 exec_hi, 0x00030003
    v_mov_b32 v200, v160
    v_mov_b32 v201, v161
    v_mov_b32 v202, v162
    v_mov_b32 v203, v163
    s_lshl_b64 exec, exec, 2
    v_mov_b32 v200, v164
    v_mov_b32 v201, v165
    v_mov_b32 v202, v166
    v_mov_b32 v203, v167
    s_lshl_b64 exec, exec, 2
    v_mov_b32 v200, v168
    v_mov_b32 v201, v169
    v_mov_b32 v202, v170
    v_mov_b32 v203, v171
    s_lshl_b64 exec, exec, 2
    v_mov_b32 v200, v172
    v_mov_b32 v201, v173
    v_mov_b32 v202, v174
    v_mov_b32 v203, v175
    s_lshl_b64 exec, exec, 2
    v_mov_b32 v200, v176
    v_mov_b32 v201, v177
    v_mov_b32 v202, v178
    v_mov_b32 v203, v179
    s_lshl_b64 exec, exec, 2
    v_mov_b32 v200, v180
    v_mov_b32 v201, v181
    v_mov_b32 v202, v182
    v_mov_b32 v203, v183
    s_lshl_b64 exec, exec, 2
    v_mov_b32 v200, v184
    v_mov_b32 v201, v185
    v_mov_b32 v202, v186
    v_mov_b32 v203, v187
    s_lshl_b64 exec, exec, 2
    v_mov_b32 v200, v188
    v_mov_b32 v201, v189
    v_mov_b32 v202, v190
    v_mov_b32 v203, v191
    s_mov_b64 exec, s[70:71]
    v_perm_b32 v200, v200, v38, s52
    v_perm_b32 v201, v201, v38, s53
    v_perm_b32 v202, v202, v38, s54
    v_perm_b32 v203, v203, v38, s55
    buffer_store_dwordx4 v[200:203], v61, s[36:39], s81 offen sc1
    buffer_store_dwordx4 v[204:207], v61, s[36:39], s81 offen offset:128 sc1
    s_waitcnt vmcnt(0)
    s_and_b32 s90, s2, 1
    s_lshr_b32 s91, s2, 2
    s_bfe_u32 s94, s2, 65537
    s_lshl_b32 s92, s91, 15
    s_lshl_b32 s93, s90, 6
    s_add_u32 s92, s92, s93
    s_lshl_b32 s93, s94, 5
    s_add_u32 s92, s92, s93
    s_add_u32 s92, s92, 4718592
    v_lshrrev_b32 v242, 1, v0
    v_lshlrev_b32 v242, 8, v242
    v_and_b32 v241, 1, v0
    v_lshl_add_u32 v242, v241, 4, v242
    buffer_load_dwordx4 v[64:67], v242, s[36:39], s92 offen sc1
    buffer_load_dwordx4 v[68:71], v242, s[36:39], s92 offen offset:128 sc1
    s_lshl_b32 s90, s90, 11
    s_lshl_b32 s91, s91, 5
    s_add_u32 s90, s90, s91
    s_lshl_b32 s94, s94, 4
    s_add_u32 s90, s90, s94
    v_and_b32 v240, 7, v1
    v_bfrev_b32 v240, v240
    v_lshrrev_b32 v240, 28, v240
    buffer_load_ushort v241, v240, s[40:43], s90 offen
    s_lshl_b32 s91, s3, 6
    s_add_u32 s91, s91, 151296
    v_and_b32 v243, 1, v1
    v_lshl_add_u32 v243, v225, 1, v243
    v_lshlrev_b32 v243, 3, v243
    v_add_u32 v243, s91, v243
    v_and_b32 v244, 7, v1
    v_lshlrev_b32 v244, 3, v244
    v_add_u32 v244, 151296, v244
    s_waitcnt vmcnt(0)
    v_perm_b32 v234, v65, v64, s56
    v_perm_b32 v232, v67, v66, s57
    v_or_b32 v234, v234, v232
    v_perm_b32 v235, v69, v68, s56
    v_perm_b32 v232, v71, v70, s57
    v_or_b32 v235, v235, v232
    v_min_u32 v232, v234, v235
    v_max_u32 v233, v234, v235
    v_xor_b32 v232, s48, v232
    v_xor_b32 v233, s48, v233
    v_or_b32 v232, v232, v233
    v_cmp_ne_u32 vcc, 0, v232
    s_cbranch_vccnz SLOW3
BACK3:
    v_and_b32 v64, s58, v64
    v_and_b32 v65, s58, v65
    v_and_b32 v66, s58, v66
    v_and_b32 v67, s58, v67
    v_and_b32 v68, s58, v68
    v_and_b32 v69, s58, v69
    v_and_b32 v70, s58, v70
    v_and_b32 v71, s58, v71
    v_permlane32_swap_b32 v64, v65
    v_permlane32_swap_b32 v66, v67
    v_permlane32_swap_b32 v68, v69
    v_permlane32_swap_b32 v70, v71
    v_add_f32 v64, v64, v65
    v_add_f32 v66, v66, v67
    v_add_f32 v68, v68, v69
    v_add_f32 v70, v70, v71
    v_permlane16_swap_b32 v64, v66
    s_nop 0
    v_permlane16_swap_b32 v68, v70
    v_add_f32 v64, v64, v66
    v_add_f32 v65, v68, v70
    s_nop 0
    v_add_f32_dpp v64, v64, v64 row_ror:2 row_mask:0xf bank_mask:0xf
    v_add_f32_dpp v65, v65, v65 row_ror:2 row_mask:0xf bank_mask:0xf
    s_nop 0
    v_add_f32_dpp v64, v64, v64 row_ror:4 row_mask:0xf bank_mask:0xf
    v_add_f32_dpp v65, v65, v65 row_ror:4 row_mask:0xf bank_mask:0xf
    s_nop 0
    v_add_f32_dpp v64, v64, v64 row_ror:8 row_mask:0xf bank_mask:0xf
    v_add_f32_dpp v65, v65, v65 row_ror:8 row_mask:0xf bank_mask:0xf
    s_mov_b32 exec_lo, 0x00030003
    s_mov_b32 exec_hi, 0x00030003
    ds_write_b64 v243, v[64:65]
    s_waitcnt lgkmcnt(0)
    s_barrier
    s_cmp_lg_u32 s3, 0
    s_cbranch_scc1 FIN
    s_mov_b32 exec_lo, 0xff
    s_mov_b32 exec_hi, 0
    ds_read_b64 v[66:67], v244 offset:0
    ds_read_b64 v[68:69], v244 offset:64
    ds_read_b64 v[70:71], v244 offset:128
    ds_read_b64 v[72:73], v244 offset:192
    v_lshlrev_b32 v236, 16, v241
    s_waitcnt lgkmcnt(0)
    v_pk_add_f32 v[66:67], v[66:67], v[68:69]
    v_pk_add_f32 v[70:71], v[70:71], v[72:73]
    v_pk_add_f32 v[66:67], v[66:67], v[70:71]
    v_cvt_pk_bf16_f32 v234, v66, v67
    v_and_b32 v67, s68, v234
    v_lshlrev_b32 v66, 16, v234
    v_add_f32 v66, v66, v236
    v_cvt_pk_bf16_f32 v234, v66, v66
    v_lshlrev_b32 v66, 16, v234
    v_add_f32 v66, v66, v67
    v_cvt_pk_bf16_f32 v234, v66, v66
    buffer_store_short v234, v240, s[44:47], s90 offen
    s_cmp_lg_u32 s2, 0
    s_cbranch_scc1 FIN
    s_mov_b32 exec_lo, 1
    v_mov_b32 v235, 0
    buffer_store_dword v38, v235, s[36:39], 0 offen sc1
FIN:
    s_endpgm
SLOW0:
    s_mov_b32 s69, 30000
LOOP0:
    s_mov_b64 exec, vcc
    buffer_load_dwordx4 v[64:67], v61, s[36:39], s73 offen sc1
    s_waitcnt vmcnt(0)
    v_min_u32 v232, v65, v67
    v_max_u32 v233, v65, v67
    v_xor_b32 v232, s48, v232
    v_xor_b32 v233, s48, v233
    v_or_b32 v232, v232, v233
    v_cmp_ne_u32 vcc, 0, v232
    s_cbranch_vccz OUT0
    s_sub_u32 s69, s69, 1
    s_cmp_lg_u32 s69, 0
    s_cbranch_scc1 LOOP0
OUT0:
    s_mov_b64 exec, -1
    s_branch BACK0
SLOW1:
    s_mov_b32 s69, 30000
LOOP1:
    s_mov_b64 exec, vcc
    buffer_load_dwordx4 v[72:75], v59, s[36:39], s77 offen sc1
    buffer_load_dwordx4 v[76:79], v59, s[36:39], s83 offen sc1
    buffer_load_dwordx4 v[80:83], v59, s[36:39], s75 offen sc1
    s_waitcnt vmcnt(0)
    v_min3_u32 v232, v73, v75, v77
    v_min3_u32 v232, v232, v79, v81
    v_min_u32 v232, v232, v83
    v_max3_u32 v233, v73, v75, v77
    v_max3_u32 v233, v233, v79, v81
    v_max_u32 v233, v233, v83
    v_xor_b32 v232, s48, v232
    v_xor_b32 v233, s48, v233
    v_or_b32 v232, v232, v233
    v_cmp_ne_u32 vcc, 0, v232
    s_cbranch_vccz OUT1
    s_sub_u32 s69, s69, 1
    s_cmp_lg_u32 s69, 0
    s_cbranch_scc1 LOOP1
OUT1:
    s_mov_b64 exec, -1
    s_branch BACK1
SLOW2:
    s_mov_b32 s69, 30000
LOOP2:
    s_mov_b64 exec, vcc
    buffer_load_dwordx4 v[104:107], v243, s[36:39], s80 offen sc1
    buffer_load_dwordx4 v[108:111], v243, s[36:39], s80 offen offset:64 sc1
    buffer_load_dwordx4 v[120:123], v244, s[36:39], s95 offen sc1
    buffer_load_dwordx4 v[124:127], v245, s[36:39], s96 offen sc1
    s_waitcnt vmcnt(0)
    v_perm_b32 v234, v105, v104, s56
    v_perm_b32 v232, v107, v106, s57
    v_or_b32 v234, v234, v232
    v_perm_b32 v235, v109, v108, s56
    v_perm_b32 v232, v111, v110, s57
    v_or_b32 v235, v235, v232
    v_min3_u32 v232, v121, v123, v125
    v_min3_u32 v232, v232, v127, v234
    v_min_u32 v232, v232, v235
    v_max3_u32 v233, v121, v123, v125
    v_max3_u32 v233, v233, v127, v234
    v_max_u32 v233, v233, v235
    v_xor_b32 v232, s48, v232
    v_xor_b32 v233, s48, v233
    v_or_b32 v232, v232, v233
    v_cmp_ne_u32 vcc, 0, v232
    s_cbranch_vccz OUT2
    s_sub_u32 s69, s69, 1
    s_cmp_lg_u32 s69, 0
    s_cbranch_scc1 LOOP2
OUT2:
    s_mov_b64 exec, -1
    s_branch BACK2
SLOW3:
    s_mov_b32 s69, 30000
LOOP3:
    s_mov_b64 exec, vcc
    buffer_load_dwordx4 v[64:67], v242, s[36:39], s92 offen sc1
    buffer_load_dwordx4 v[68:71], v242, s[36:39], s92 offen offset:128 sc1
    s_waitcnt vmcnt(0)
    v_perm_b32 v234, v65, v64, s56
    v_perm_b32 v232, v67, v66, s57
    v_or_b32 v234, v234, v232
    v_perm_b32 v235, v69, v68, s56
    v_perm_b32 v232, v71, v70, s57
    v_or_b32 v235, v235, v232
    v_min_u32 v232, v234, v235
    v_max_u32 v233, v234, v235
    v_xor_b32 v232, s48, v232
    v_xor_b32 v233, s48, v233
    v_or_b32 v232, v232, v233
    v_cmp_ne_u32 vcc, 0, v232
    s_cbranch_vccz OUT3
    s_sub_u32 s69, s69, 1
    s_cmp_lg_u32 s69, 0
    s_cbranch_scc1 LOOP3
OUT3:
    s_mov_b64 exec, -1
    s_branch BACK3
DONE:
    s_endpgm
CODE_END:
.section .rodata,"a"
.p2align 6
.amdhsa_kernel parallel_sum__gqa_block_cached__swiglu_ffn__decode_kernel
  .amdhsa_next_free_vgpr 512
  .amdhsa_next_free_sgpr 102
  .amdhsa_accum_offset 256
  .amdhsa_float_denorm_mode_32 3
  .amdhsa_group_segment_fixed_size 0
  .amdhsa_kernarg_size 96
  .amdhsa_user_sgpr_count 2
  .amdhsa_user_sgpr_kernarg_segment_ptr 1
  .amdhsa_system_sgpr_workgroup_id_x 1
.end_amdhsa_kernel
```
